```python
import torch

def _softmax(x, axis=-1):
    return torch.softmax(x, dim=axis)
def _gelu(x):
    return torch.nn.functional.gelu(x, approximate="tanh")
def _silu(x):
    return torch.nn.functional.silu(x)
def _sigmoid(x):
    return torch.sigmoid(x)
def _layernorm(x, axis=-1, eps=1e-5):
    m = x.mean(dim=axis, keepdim=True)
    v = x.var(dim=axis, keepdim=True, unbiased=False)
    return (x - m) / torch.sqrt(v + eps)
def _scatter_add(tgt, idx, src, axis=0):
    return tgt.clone().index_add_(axis, idx, src)
def _segment_sum(src, seg, n):
    out = torch.zeros((n,) + src.shape[1:], dtype=src.dtype)
    return out.index_add_(0, seg, src)
def _pad(x, pw):
    flat = tuple(v for pair in reversed(pw) for v in pair)
    return torch.nn.functional.pad(x, flat)

kernel_name = 'gated_mix__ssm_conv_s4d__ssm_conv_s4__prompt'

def setup_inputs():

    _w = (lambda a: (lambda t: t.to(torch.bfloat16) if t.is_floating_point() else t)(torch.as_tensor(a)))
    def _A_setup():
        Bsz, L, D, N = 1, 2048, 512, 128
        return {
            "u": _w((lambda *s: torch.randn(*s, dtype=torch.bfloat16) * 0.05)(Bsz, L, D)),
            "log_A_real": _w((lambda *s: torch.randn(*s, dtype=torch.bfloat16) * 3.2)(D, N) * 0.5),
            "A_imag": _w((lambda *s: torch.randn(*s, dtype=torch.bfloat16) * 0.05)(D, N) * 3.14),
            "C_real": _w((lambda *s: torch.randn(*s, dtype=torch.bfloat16) * 0.1)(D, N) / N ** 0.5),
            "C_imag": _w((lambda *s: torch.randn(*s, dtype=torch.bfloat16) * 0.1)(D, N) / N ** 0.5),
            "log_dt": _w((lambda *s: torch.randn(*s, dtype=torch.bfloat16) * 0.05)(D) * 0.5 - 4.0),
            "D_skip": _w((lambda *s: torch.randn(*s, dtype=torch.bfloat16) * 0.05)(D)),
        }
    _A_in = _A_setup()

    def _B_setup():
        B, L, D, N = 1, 2048, 512, 128
        A_re = -(lambda _x: torch.exp(torch.as_tensor(_x)))((lambda *s: torch.randn(*s, dtype=torch.bfloat16) * 3.2)(D, N))
        A_im = torch.pi * (lambda *s: torch.randn(*s, dtype=torch.bfloat16) * 0.05)(D, N)
        B_re = (lambda *s: torch.randn(*s, dtype=torch.bfloat16) * 0.1)(D, N)
        B_im = (lambda *s: torch.randn(*s, dtype=torch.bfloat16) * 0.1)(D, N)
        C_re = (lambda *s: torch.randn(*s, dtype=torch.bfloat16) * 0.1)(D, N)
        C_im = (lambda *s: torch.randn(*s, dtype=torch.bfloat16) * 0.1)(D, N)
        log_dt = (lambda *s: torch.randn(*s, dtype=torch.bfloat16) * 0.05)(D) * 0.5 - 4.0
        Dskip = (lambda *s: torch.randn(*s, dtype=torch.bfloat16) * 0.05)(D)
        return {
            "u": _w((lambda *s: torch.randn(*s, dtype=torch.bfloat16) * 0.05)(B, L, D)),
            "A_re": _w(A_re),
            "A_im": _w(A_im),
            "B_re": _w(B_re),
            "B_im": _w(B_im),
            "C_re": _w(C_re),
            "C_im": _w(C_im),
            "log_dt": _w(log_dt),
            "Dskip": _w(Dskip),
        }
    _B_in = _B_setup()

    return {
        "A_u": _A_in["u"],
        "A_log_A_real": _A_in["log_A_real"],
        "A_A_imag": _A_in["A_imag"],
        "A_C_real": _A_in["C_real"],
        "A_C_imag": _A_in["C_imag"],
        "A_log_dt": _A_in["log_dt"],
        "A_D_skip": _A_in["D_skip"],
        "B_u": _B_in["u"],
        "B_A_re": _B_in["A_re"],
        "B_A_im": _B_in["A_im"],
        "B_B_re": _B_in["B_re"],
        "B_B_im": _B_in["B_im"],
        "B_C_re": _B_in["C_re"],
        "B_C_im": _B_in["C_im"],
        "B_log_dt": _B_in["log_dt"],
        "B_Dskip": _B_in["Dskip"],
        "gate_w": _w((lambda *s: torch.randn(*s, dtype=torch.bfloat16) * 0.05)(512) * 16.0),
    }

def reference(A_u, A_log_A_real, A_A_imag, A_C_real, A_C_imag, A_log_dt, A_D_skip, B_u, B_A_re, B_A_im, B_B_re, B_B_im, B_C_re, B_C_im, B_log_dt, B_Dskip, gate_w):
    def _A_ref(u, log_A_real, A_imag, C_real, C_imag, log_dt, D_skip):
        L = u.shape[1]
        dt = torch.exp(log_dt)
        A = -torch.exp(log_A_real) + 1j * A_imag
        C = (C_real + 1j * C_imag) * dt[:, None]
        pos = (lambda x, dt: x.to(dt))(torch.arange(L), log_dt.dtype)
        P = torch.exp((A * dt[:, None])[:, :, None] * pos[None, None, :])
        K = 2.0 * torch.einsum("dn,dnl->dl", C, P).real
        L2 = 2 * L
        u_t = (lambda x, *d: x.permute(*d))(u, 0, 2, 1)
        Kf = (lambda x, *a, **k: torch.fft.rfft(x.float(), *a, **k))(K, L2)
        Uf = (lambda x, *a, **k: torch.fft.rfft(x.float(), *a, **k))(u_t, L2)
        y = (lambda x, *a, **k: torch.fft.irfft(x, *a, **k).to(torch.bfloat16))(Uf * Kf[None, :, :], L2)[:, :, :L]
        y = (lambda x, *d: x.permute(*d))(y, 0, 2, 1)
        return y + u * D_skip[None, None, :]

    def _B_ref(u, A_re, A_im, B_re, B_im, C_re, C_im, log_dt, Dskip):
        Bsz, L, D = u.shape
        dt = torch.exp(log_dt)[:, None]
        A = A_re + 1j * A_im
        Bc = B_re + 1j * B_im
        Cc = C_re + 1j * C_im
        logdA = dt * A
        dB = dt * Bc
        l = (lambda x, dt: x.to(dt))(torch.arange(L), A_re.dtype)
        P = torch.exp(logdA[:, :, None] * l[None, None, :])
        K = torch.einsum("dn,dnl,dn->dl", Cc, P, dB).real
        L2 = 2 * L
        Kp = _pad(K, ((0, 0), (0, L)))
        up = (lambda x, *d: x.permute(*d))(u, 0, 2, 1)
        up = _pad(up, ((0, 0), (0, 0), (0, L)))
        Kf = (lambda x, axes=(-2,-1): torch.fft.rfft2(x.float(), dim=axes))(Kp[:, None, :], axes=(-2, -1))
        Uf = (lambda x, axes=(-2,-1): torch.fft.rfft2(x.float(), dim=axes))(up[:, :, None, :], axes=(-2, -1))
        Yf = Uf * Kf[None, :, :, :]
        y = (lambda x, s, axes=(-2,-1): torch.fft.irfft2(x, s=s, dim=axes).to(torch.bfloat16))(Yf, (1, L2), axes=(-2, -1))[:, :, 0, :L]
        y = (lambda x, *d: x.permute(*d))(y, 0, 2, 1) + u * Dskip[None, None, :]
        return y

    x = A_u
    g = _sigmoid((x * gate_w).sum(-1, keepdims=True))
    a = _A_ref(x, A_log_A_real, A_A_imag, A_C_real, A_C_imag, A_log_dt, A_D_skip)
    b = _B_ref(x, B_A_re, B_A_im, B_B_re, B_B_im, B_C_re, B_C_im, B_log_dt, B_Dskip)
    return g * a + (1 - g) * b
```

```asm
; @launch grid=(256,1,1) block=(512,1,1) lds=142336
.amdgcn_target "amdgcn-amd-amdhsa--gfx950"
.text
.globl gated_mix__ssm_conv_s4d__ssm_conv_s4__prompt_kernel
.p2align 8
.type gated_mix__ssm_conv_s4d__ssm_conv_s4__prompt_kernel,@function
gated_mix__ssm_conv_s4d__ssm_conv_s4__prompt_kernel:
s_cmp_ge_u32 s2, 256
s_cbranch_scc1 L_end
s_load_dwordx16 s[8:23], s[0:1], 0
s_load_dwordx16 s[24:39], s[0:1], 64
s_load_dwordx8 s[40:47], s[0:1], 128
v_lshrrev_b32 v20, 6, v0
v_and_b32 v1, 63, v0
s_and_b32 s56, s2, 7
v_readfirstlane_b32 s48, v20
s_lshl_b32 s56, s56, 6
s_lshr_b32 s57, s2, 3
s_lshl_b32 s57, s57, 1
s_add_u32 s53, s56, s57
s_lshr_b32 s49, s48, 2
s_bfe_u32 s50, s48, 0x10001
s_and_b32 s51, s48, 1
s_and_b32 s52, s48, 3
s_mul_i32 s56, s49, 3
s_xor_b32 s52, s52, s56
s_lshl_b32 s56, s2, 2
s_and_b32 s57, s48, 3
s_add_u32 s59, s56, s57
s_lshl_b32 s56, s59, 11
v_lshlrev_b32 v21, 5, v1
v_and_b32 v22, 0x3ff, v21
v_add_u32 v21, s56, v21
s_add_u32 s56, s53, s49
s_lshl_b32 s56, s56, 8
s_lshl_b32 s57, s51, 7
s_add_u32 s56, s56, s57
v_lshlrev_b32 v23, 1, v1
v_add_u32 v23, s56, v23
s_lshl_b32 s58, s53, 1
v_lshlrev_b32 v6, 10, v0
v_add_u32 v6, s58, v6
s_lshl_b32 s70, s48, 8
s_add_u32 s71, s70, 49152
s_cmp_eq_u32 s50, 0
s_waitcnt lgkmcnt(0)
s_load_dword s3, s[46:47], 0x4000
s_cmp_eq_u32 s49, 0
s_cbranch_scc0 L_nogl
global_load_dwordx4 v[144:147], v21, s[8:9]
global_load_dwordx4 v[148:151], v21, s[8:9] offset:16
global_load_dwordx4 v[152:155], v22, s[40:41]
global_load_dwordx4 v[156:159], v22, s[40:41] offset:16
L_nogl:
s_cmp_eq_u32 s50, 0
s_cselect_b64 s[60:61], s[10:11], s[24:25]
s_cselect_b64 s[62:63], s[12:13], s[26:27]
s_cselect_b64 s[64:65], s[14:15], s[32:33]
s_cselect_b64 s[66:67], s[16:17], s[34:35]
s_cselect_b64 s[68:69], s[18:19], s[36:37]
global_load_ushort v40, v23, s[60:61]
global_load_ushort v41, v23, s[62:63]
global_load_ushort v42, v23, s[64:65]
global_load_ushort v43, v23, s[66:67]
global_load_ushort v44, v23, s[28:29]
global_load_ushort v45, v23, s[30:31]
s_load_dword s72, s[68:69], s58
s_load_dword s54, s[20:21], s58
s_load_dword s55, s[38:39], s58
v_mov_b32 v24, 0
v_mov_b32 v25, 0
v_mov_b32 v26, 0
v_mov_b32 v27, 0
v_lshlrev_b32 v28, 4, v0
v_add_u32 v28, 109568, v28
ds_write_b128 v28, v[24:27] offset:0
ds_write_b128 v28, v[24:27] offset:8192
ds_write_b128 v28, v[24:27] offset:16384
v_and_b32 v46, 15, v1
v_lshrrev_b32 v47, 4, v1
v_lshlrev_b32 v7, 1, v0
v_add_u32 v7, 123072, v7
s_mul_i32 s56, s49, 4672
s_add_u32 s56, s56, 122496
v_lshlrev_b32 v48, 5, v46
v_lshl_add_u32 v48, v47, 4, v48
v_add_u32 v10, s56, v48
v_bfe_u32 v48, v46, 1, 2
v_xor_b32 v48, v48, v47
v_lshlrev_b32 v48, 4, v48
v_lshl_add_u32 v48, v46, 6, v48
s_lshl_b32 s56, s49, 2
s_add_u32 s56, s56, s52
s_lshl_b32 s56, s56, 11
s_add_u32 s56, s56, 40960
v_add_u32 v11, s56, v48
v_lshrrev_b32 v48, 2, v46
v_xor_b32 v48, v48, v47
v_lshlrev_b32 v48, 4, v48
v_lshl_add_u32 v48, v46, 6, v48
v_add_u32 v12, 134144, v48
v_lshrrev_b32 v48, 3, v0
v_and_b32 v48, 12, v48
v_xor_b32 v48, v48, v0
v_lshlrev_b32 v48, 2, v48
v_add_u32 v8, 40960, v48
v_lshrrev_b32 v48, 4, v0
v_and_b32 v48, 12, v48
v_xor_b32 v48, v48, v0
v_lshlrev_b32 v48, 2, v48
v_add_u32 v9, 134144, v48
global_load_dword v2, v6, s[8:9]
v_and_b32 v48, 31, v1
v_lshrrev_b32 v49, 5, v1
v_mul_u32_u24 v50, 2064, v48
v_lshl_add_u32 v50, v49, 4, v50
v_add_u32 v27, s70, v50
v_add_u32 v28, 66048, v27
s_lshr_b32 s56, s48, 1
s_mul_i32 s56, s56, 3232
s_add_u32 s57, s56, 109568
v_lshlrev_b32 v50, 4, v48
v_sub_u32 v16, s57, v50
v_lshlrev_b32 v50, 3, v49
v_sub_u32 v31, v16, v50
v_lshlrev_b32 v50, 2, v48
v_sub_u32 v17, s57, v50
v_lshlrev_b32 v50, 1, v48
v_sub_u32 v18, s57, v50
v_mul_u32_u24 v50, 2064, v47
v_lshl_add_u32 v50, v46, 4, v50
s_xor_b32 s56, s70, 256
v_add_u32 v30, s56, v50
v_add_u32 v29, s70, v50
s_lshr_b32 s56, s52, 1
s_lshl1_add_u32 s56, s49, s56
s_lshl_b32 s56, s56, 11
v_lshl_add_u32 v38, v1, 4, s56
s_add_u32 s56, s56, 134144
v_xor_b32 v39, v47, v1
v_lshl_add_u32 v39, v39, 4, s56
s_mul_i32 s56, s49, 6464
s_add_u32 s56, s56, 109568
s_lshl_b32 s57, s52, 7
s_sub_u32 s57, 352, s57
s_cmp_eq_u32 s52, 3
s_cselect_b32 s57, 32, s57
s_add_u32 s57, s57, s56
v_and_b32 v50, 1, v46
v_mul_u32_u24 v50, 1214, v50
v_lshl_add_u32 v50, v47, 4, v50
v_add_u32 v50, s57, v50
v_lshlrev_b32 v51, 1, v46
v_sub_u32 v13, v50, v51
v_add_u32 v14, 3232, v13
v_lshl_add_u32 v50, v47, 4, s56
v_lshlrev_b32 v51, 2, v46
v_sub_u32 v204, v50, v51
v_add_u32 v204, 2908, v204
v_add_u32 v205, 3232, v204
v_mov_b32 v206, s56
s_mul_i32 s56, s49, 5376
s_add_u32 s56, s56, 29184
v_mul_u32_u24 v51, 336, v46
v_add_u32 v51, s56, v51
v_lshl_add_u32 v36, v47, 4, v51
v_mov_b32 v37, v36
s_cmp_eq_u32 s52, 1
s_cbranch_scc0 L_nor1
v_lshlrev_b32 v51, 3, v46
v_sub_u32 v13, v50, v51
v_add_u32 v13, 2456, v13
s_mul_i32 s56, s49, 14592
v_mul_u32_u24 v51, 912, v46
v_add_u32 v51, s56, v51
v_lshl_add_u32 v36, v47, 5, v51
v_lshl_add_u32 v37, v47, 4, v51
L_nor1:
v_lshlrev_b32 v19, 3, v47
v_sub_u32 v19, v46, v19
s_waitcnt vmcnt(1) lgkmcnt(0)
s_add_u32 s3, s3, 1
s_cmp_eq_u32 s49, 0
s_cbranch_scc0 L_nogate
v_dot2_f32_bf16 v20, v144, v152, 0
v_dot2_f32_bf16 v21, v145, v153, 0
v_dot2_f32_bf16 v20, v146, v154, v20
v_dot2_f32_bf16 v21, v147, v155, v21
v_dot2_f32_bf16 v20, v148, v156, v20
v_dot2_f32_bf16 v21, v149, v157, v21
v_dot2_f32_bf16 v20, v150, v158, v20
v_dot2_f32_bf16 v21, v151, v159, v21
s_nop 2
v_add_f32 v20, v20, v21
s_nop 1
v_add_f32_dpp v20, v20, v20 row_shr:1 row_mask:0xf bank_mask:0xf bound_ctrl:0
s_nop 1
v_add_f32_dpp v20, v20, v20 row_shr:2 row_mask:0xf bank_mask:0xf bound_ctrl:0
s_nop 1
v_add_f32_dpp v20, v20, v20 row_shr:4 row_mask:0xf bank_mask:0xf bound_ctrl:0
s_nop 1
v_add_f32_dpp v20, v20, v20 row_shr:8 row_mask:0xf bank_mask:0xf bound_ctrl:0
s_nop 1
v_add_f32_dpp v20, v20, v20 row_bcast:15 row_mask:0xa bank_mask:0xf
v_cvt_pk_bf16_f32 v20, v20, v20
v_and_b32 v20, 0xffff0000, v20
v_mul_f32 v20, 0xbfb8aa3b, v20
v_exp_f32 v20, v20
s_lshl_b32 s56, s59, 3
v_mov_b32 v22, s56
v_add_f32 v20, 1.0, v20
v_rcp_f32 v20, v20
s_nop 1
v_readlane_b32 s56, v20, 31
v_mov_b32 v21, s3
s_mov_b32 exec_lo, 0
s_mov_b32 exec_hi, 0x80000000
v_cvt_pk_bf16_f32 v20, s56, v20
global_store_dwordx2 v22, v[20:21], s[46:47] sc1
s_mov_b64 exec, -1
L_nogate:
s_waitcnt lgkmcnt(0)
s_lshl_b32 s56, s72, 16
s_and_b32 s57, s72, 0xffff0000
s_cmp_eq_u32 s49, 0
s_cselect_b32 s56, s56, s57
v_mov_b32 v46, 0x3fb8aa3b
v_mul_f32 v47, s56, v46
v_exp_f32 v47, v47
v_lshlrev_b32 v40, 16, v40
v_lshlrev_b32 v41, 16, v41
v_lshlrev_b32 v42, 16, v42
v_lshlrev_b32 v43, 16, v43
v_lshlrev_b32 v44, 16, v44
v_lshlrev_b32 v45, 16, v45
v_cvt_pk_bf16_f32 v47, v47, v47
v_and_b32 v47, 0xffff0000, v47
s_lshl_b32 s74, s55, 16
s_and_b32 s75, s55, 0xffff0000
s_lshl_b32 s76, s54, 16
s_and_b32 s77, s54, 0xffff0000
v_add_u32 v15, 524288, v6
global_load_dword v3, v15, s[8:9]
s_cmp_eq_u32 s50, 0
s_cbranch_scc0 L_brB
v_mul_f32 v40, v40, v46
v_exp_f32 v40, v40
v_add_f32 v48, v47, v47
v_mul_f32 v50, v42, v48
v_mul_f32 v51, -v43, v48
v_cvt_pk_bf16_f32 v40, v40, v40
v_and_b32 v40, 0xffff0000, v40
v_xor_b32 v40, 0x80000000, v40
s_branch L_brJ
L_brB:
v_mul_f32 v44, v44, v47
v_mul_f32 v45, v45, v47
v_pk_mul_f32 v[50:51], v[42:43], v[44:45] op_sel:[0,0] op_sel_hi:[1,0]
v_pk_fma_f32 v[50:51], v[42:43], v[44:45], v[50:51] op_sel:[1,1,0] op_sel_hi:[0,1,1] neg_lo:[1,0,0]
v_xor_b32 v51, 0x80000000, v51
L_brJ:
v_mul_f32 v40, v40, v47
v_mul_f32 v41, v41, v47
v_mul_f32 v40, v40, v46
v_mul_f32 v41, 0x3e22f983, v41
v_mul_f32 v42, 0x43800000, v40
v_mul_f32 v43, 0x43800000, v41
v_fract_f32 v43, v43
v_exp_f32 v42, v42
v_cos_f32 v56, v43
v_sin_f32 v57, v43
s_nop 0
v_mul_f32 v56, v42, v56
v_mul_f32 v57, v42, v57
v_fract_f32 v43, v41
v_exp_f32 v42, v40
v_cos_f32 v52, v43
v_sin_f32 v53, v43
s_nop 0
v_mul_f32 v52, v42, v52
v_mul_f32 v53, v42, v53
v_mul_f32 v42, 0x41000000, v40
v_mul_f32 v43, 0x41000000, v41
v_fract_f32 v43, v43
v_exp_f32 v42, v42
v_cos_f32 v54, v43
v_sin_f32 v55, v43
s_nop 0
v_mul_f32 v54, v42, v54
v_mul_f32 v55, v42, v55
s_mov_b32 m0, s71
v_cvt_pk_bf16_f32 v20, v50, v51
ds_write_addtid_b32 v20 offset:16896
v_pk_mul_f32 v[58:59], v[52:53], v[52:53] op_sel:[0,0] op_sel_hi:[1,0]
v_pk_mul_f32 v[78:79], v[50:51], v[56:57] op_sel:[0,0] op_sel_hi:[1,0]
v_pk_mul_f32 v[64:65], v[50:51], v[52:53] op_sel:[0,0] op_sel_hi:[1,0]
v_pk_fma_f32 v[58:59], v[52:53], v[52:53], v[58:59] op_sel:[1,1,0] op_sel_hi:[0,1,1] neg_lo:[1,0,0]
v_pk_fma_f32 v[78:79], v[50:51], v[56:57], v[78:79] op_sel:[1,1,0] op_sel_hi:[0,1,1] neg_hi:[1,0,0]
v_pk_fma_f32 v[64:65], v[50:51], v[52:53], v[64:65] op_sel:[1,1,0] op_sel_hi:[0,1,1] neg_hi:[1,0,0]
v_cvt_pk_bf16_f32 v21, v78, v79
ds_write_addtid_b32 v21 offset:33408
v_cvt_pk_bf16_f32 v22, v64, v65
ds_write_addtid_b32 v22 offset:18960
v_pk_mul_f32 v[60:61], v[58:59], v[58:59] op_sel:[0,0] op_sel_hi:[1,0]
v_pk_mul_f32 v[86:87], v[78:79], v[56:57] op_sel:[0,0] op_sel_hi:[1,0]
v_pk_mul_f32 v[66:67], v[50:51], v[58:59] op_sel:[0,0] op_sel_hi:[1,0]
v_pk_mul_f32 v[68:69], v[64:65], v[58:59] op_sel:[0,0] op_sel_hi:[1,0]
v_pk_mul_f32 v[80:81], v[78:79], v[58:59] op_sel:[0,0] op_sel_hi:[1,0]
v_pk_fma_f32 v[60:61], v[58:59], v[58:59], v[60:61] op_sel:[1,1,0] op_sel_hi:[0,1,1] neg_lo:[1,0,0]
v_pk_fma_f32 v[86:87], v[78:79], v[56:57], v[86:87] op_sel:[1,1,0] op_sel_hi:[0,1,1] neg_hi:[1,0,0]
v_pk_fma_f32 v[66:67], v[50:51], v[58:59], v[66:67] op_sel:[1,1,0] op_sel_hi:[0,1,1] neg_hi:[1,0,0]
v_pk_fma_f32 v[68:69], v[64:65], v[58:59], v[68:69] op_sel:[1,1,0] op_sel_hi:[0,1,1] neg_hi:[1,0,0]
v_pk_fma_f32 v[80:81], v[78:79], v[58:59], v[80:81] op_sel:[1,1,0] op_sel_hi:[0,1,1] neg_hi:[1,0,0]
v_cvt_pk_bf16_f32 v23, v86, v87
ds_write_addtid_b32 v23 offset:41664
v_cvt_pk_bf16_f32 v24, v66, v67
ds_write_addtid_b32 v24 offset:21024
v_cvt_pk_bf16_f32 v25, v68, v69
ds_write_addtid_b32 v25 offset:23088
v_cvt_pk_bf16_f32 v20, v80, v81
ds_write_addtid_b32 v20 offset:35472
v_pk_mul_f32 v[90:91], v[86:87], v[56:57] op_sel:[0,0] op_sel_hi:[1,0]
v_pk_mul_f32 v[70:71], v[50:51], v[60:61] op_sel:[0,0] op_sel_hi:[1,0]
v_pk_mul_f32 v[72:73], v[64:65], v[60:61] op_sel:[0,0] op_sel_hi:[1,0]
v_pk_mul_f32 v[74:75], v[66:67], v[60:61] op_sel:[0,0] op_sel_hi:[1,0]
v_pk_mul_f32 v[76:77], v[68:69], v[60:61] op_sel:[0,0] op_sel_hi:[1,0]
v_pk_fma_f32 v[90:91], v[86:87], v[56:57], v[90:91] op_sel:[1,1,0] op_sel_hi:[0,1,1] neg_hi:[1,0,0]
v_pk_fma_f32 v[70:71], v[50:51], v[60:61], v[70:71] op_sel:[1,1,0] op_sel_hi:[0,1,1] neg_hi:[1,0,0]
v_pk_fma_f32 v[72:73], v[64:65], v[60:61], v[72:73] op_sel:[1,1,0] op_sel_hi:[0,1,1] neg_hi:[1,0,0]
v_pk_fma_f32 v[74:75], v[66:67], v[60:61], v[74:75] op_sel:[1,1,0] op_sel_hi:[0,1,1] neg_hi:[1,0,0]
v_pk_fma_f32 v[76:77], v[68:69], v[60:61], v[76:77] op_sel:[1,1,0] op_sel_hi:[0,1,1] neg_hi:[1,0,0]
v_cvt_pk_bf16_f32 v21, v90, v91
ds_write_addtid_b32 v21 offset:45792
v_cvt_pk_bf16_f32 v22, v70, v71
ds_write_addtid_b32 v22 offset:25152
v_cvt_pk_bf16_f32 v23, v72, v73
ds_write_addtid_b32 v23 offset:27216
v_cvt_pk_bf16_f32 v24, v74, v75
ds_write_addtid_b32 v24 offset:29280
v_cvt_pk_bf16_f32 v25, v76, v77
ds_write_addtid_b32 v25 offset:31344
v_pk_mul_f32 v[94:95], v[90:91], v[56:57] op_sel:[0,0] op_sel_hi:[1,0]
v_pk_mul_f32 v[82:83], v[78:79], v[60:61] op_sel:[0,0] op_sel_hi:[1,0]
v_pk_mul_f32 v[84:85], v[80:81], v[60:61] op_sel:[0,0] op_sel_hi:[1,0]
v_pk_mul_f32 v[88:89], v[86:87], v[60:61] op_sel:[0,0] op_sel_hi:[1,0]
v_pk_mul_f32 v[92:93], v[90:91], v[60:61] op_sel:[0,0] op_sel_hi:[1,0]
v_pk_fma_f32 v[94:95], v[90:91], v[56:57], v[94:95] op_sel:[1,1,0] op_sel_hi:[0,1,1] neg_hi:[1,0,0]
v_pk_fma_f32 v[82:83], v[78:79], v[60:61], v[82:83] op_sel:[1,1,0] op_sel_hi:[0,1,1] neg_hi:[1,0,0]
v_pk_fma_f32 v[84:85], v[80:81], v[60:61], v[84:85] op_sel:[1,1,0] op_sel_hi:[0,1,1] neg_hi:[1,0,0]
v_pk_fma_f32 v[88:89], v[86:87], v[60:61], v[88:89] op_sel:[1,1,0] op_sel_hi:[0,1,1] neg_hi:[1,0,0]
v_pk_fma_f32 v[92:93], v[90:91], v[60:61], v[92:93] op_sel:[1,1,0] op_sel_hi:[0,1,1] neg_hi:[1,0,0]
v_cvt_pk_bf16_f32 v20, v94, v95
ds_write_addtid_b32 v20 offset:49920
v_cvt_pk_bf16_f32 v21, v82, v83
ds_write_addtid_b32 v21 offset:37536
v_cvt_pk_bf16_f32 v22, v84, v85
ds_write_addtid_b32 v22 offset:39600
v_cvt_pk_bf16_f32 v23, v88, v89
ds_write_addtid_b32 v23 offset:43728
v_cvt_pk_bf16_f32 v24, v92, v93
ds_write_addtid_b32 v24 offset:47856
v_mov_b32 v26, 0x3f80
v_pk_mul_f32 v[96:97], v[94:95], v[56:57] op_sel:[0,0] op_sel_hi:[1,0]
v_pk_mul_f32 v[108:109], v[54:55], v[54:55] op_sel:[0,0] op_sel_hi:[1,0]
v_pk_fma_f32 v[96:97], v[94:95], v[56:57], v[96:97] op_sel:[1,1,0] op_sel_hi:[0,1,1] neg_hi:[1,0,0]
v_pk_fma_f32 v[108:109], v[54:55], v[54:55], v[108:109] op_sel:[1,1,0] op_sel_hi:[0,1,1] neg_lo:[1,0,0]
v_cvt_pk_bf16_f32 v25, v96, v97
ds_write_addtid_b32 v25 offset:51984
v_pk_mul_f32 v[98:99], v[96:97], v[56:57] op_sel:[0,0] op_sel_hi:[1,0]
v_pk_mul_f32 v[110:111], v[108:109], v[54:55] op_sel:[0,0] op_sel_hi:[1,0]
v_pk_mul_f32 v[62:63], v[108:109], v[108:109] op_sel:[0,0] op_sel_hi:[1,0]
v_pk_fma_f32 v[98:99], v[96:97], v[56:57], v[98:99] op_sel:[1,1,0] op_sel_hi:[0,1,1] neg_hi:[1,0,0]
v_pk_fma_f32 v[110:111], v[108:109], v[54:55], v[110:111] op_sel:[1,1,0] op_sel_hi:[0,1,1] neg_lo:[1,0,0]
v_pk_fma_f32 v[62:63], v[108:109], v[108:109], v[62:63] op_sel:[1,1,0] op_sel_hi:[0,1,1] neg_lo:[1,0,0]
v_cvt_pk_bf16_f32 v20, v98, v99
ds_write_addtid_b32 v20 offset:54048
v_pk_mul_f32 v[100:101], v[98:99], v[56:57] op_sel:[0,0] op_sel_hi:[1,0]
v_pk_mul_f32 v[114:115], v[54:55], v[62:63] op_sel:[0,0] op_sel_hi:[1,0]
v_pk_mul_f32 v[116:117], v[108:109], v[62:63] op_sel:[0,0] op_sel_hi:[1,0]
v_pk_mul_f32 v[118:119], v[110:111], v[62:63] op_sel:[0,0] op_sel_hi:[1,0]
v_pk_fma_f32 v[100:101], v[98:99], v[56:57], v[100:101] op_sel:[1,1,0] op_sel_hi:[0,1,1] neg_hi:[1,0,0]
v_pk_fma_f32 v[114:115], v[54:55], v[62:63], v[114:115] op_sel:[1,1,0] op_sel_hi:[0,1,1] neg_lo:[1,0,0]
v_pk_fma_f32 v[116:117], v[108:109], v[62:63], v[116:117] op_sel:[1,1,0] op_sel_hi:[0,1,1] neg_lo:[1,0,0]
v_pk_fma_f32 v[118:119], v[110:111], v[62:63], v[118:119] op_sel:[1,1,0] op_sel_hi:[0,1,1] neg_lo:[1,0,0]
v_cvt_pk_bf16_f32 v21, v100, v101
ds_write_addtid_b32 v21 offset:56112
v_pk_mul_f32 v[102:103], v[100:101], v[56:57] op_sel:[0,0] op_sel_hi:[1,0]
v_pk_mul_f32 v[104:105], v[62:63], v[62:63] op_sel:[0,0] op_sel_hi:[1,0]
v_pk_fma_f32 v[102:103], v[100:101], v[56:57], v[102:103] op_sel:[1,1,0] op_sel_hi:[0,1,1] neg_hi:[1,0,0]
v_pk_fma_f32 v[104:105], v[62:63], v[62:63], v[104:105] op_sel:[1,1,0] op_sel_hi:[0,1,1] neg_lo:[1,0,0]
v_cvt_pk_bf16_f32 v22, v102, v103
ds_write_addtid_b32 v22 offset:58176
s_mov_b32 m0, s70
s_nop 0
ds_write_addtid_b32 v26 offset:0
v_cvt_pk_bf16_f32 v23, v54, v55
ds_write_addtid_b32 v23 offset:2064
v_cvt_pk_bf16_f32 v24, v108, v109
ds_write_addtid_b32 v24 offset:4128
v_cvt_pk_bf16_f32 v25, v110, v111
ds_write_addtid_b32 v25 offset:6192
v_cvt_pk_bf16_f32 v20, v62, v63
ds_write_addtid_b32 v20 offset:8256
v_cvt_pk_bf16_f32 v21, v114, v115
ds_write_addtid_b32 v21 offset:10320
v_cvt_pk_bf16_f32 v22, v116, v117
ds_write_addtid_b32 v22 offset:12384
v_cvt_pk_bf16_f32 v23, v118, v119
ds_write_addtid_b32 v23 offset:14448
v_cvt_pk_bf16_f32 v24, v104, v105
ds_write_addtid_b32 v24 offset:16512
v_pk_mul_f32 v[106:107], v[114:115], v[62:63] op_sel:[0,0] op_sel_hi:[1,0]
v_pk_mul_f32 v[108:109], v[116:117], v[62:63] op_sel:[0,0] op_sel_hi:[1,0]
v_pk_mul_f32 v[110:111], v[118:119], v[62:63] op_sel:[0,0] op_sel_hi:[1,0]
v_pk_mul_f32 v[112:113], v[104:105], v[62:63] op_sel:[0,0] op_sel_hi:[1,0]
v_pk_fma_f32 v[106:107], v[114:115], v[62:63], v[106:107] op_sel:[1,1,0] op_sel_hi:[0,1,1] neg_lo:[1,0,0]
v_pk_fma_f32 v[108:109], v[116:117], v[62:63], v[108:109] op_sel:[1,1,0] op_sel_hi:[0,1,1] neg_lo:[1,0,0]
v_pk_fma_f32 v[110:111], v[118:119], v[62:63], v[110:111] op_sel:[1,1,0] op_sel_hi:[0,1,1] neg_lo:[1,0,0]
v_pk_fma_f32 v[112:113], v[104:105], v[62:63], v[112:113] op_sel:[1,1,0] op_sel_hi:[0,1,1] neg_lo:[1,0,0]
v_cvt_pk_bf16_f32 v25, v106, v107
ds_write_addtid_b32 v25 offset:18576
v_cvt_pk_bf16_f32 v20, v108, v109
ds_write_addtid_b32 v20 offset:20640
v_cvt_pk_bf16_f32 v21, v110, v111
ds_write_addtid_b32 v21 offset:22704
v_cvt_pk_bf16_f32 v22, v112, v113
ds_write_addtid_b32 v22 offset:24768
v_pk_mul_f32 v[114:115], v[106:107], v[62:63] op_sel:[0,0] op_sel_hi:[1,0]
v_pk_mul_f32 v[116:117], v[108:109], v[62:63] op_sel:[0,0] op_sel_hi:[1,0]
v_pk_mul_f32 v[118:119], v[110:111], v[62:63] op_sel:[0,0] op_sel_hi:[1,0]
v_pk_mul_f32 v[104:105], v[112:113], v[62:63] op_sel:[0,0] op_sel_hi:[1,0]
v_pk_fma_f32 v[114:115], v[106:107], v[62:63], v[114:115] op_sel:[1,1,0] op_sel_hi:[0,1,1] neg_lo:[1,0,0]
v_pk_fma_f32 v[116:117], v[108:109], v[62:63], v[116:117] op_sel:[1,1,0] op_sel_hi:[0,1,1] neg_lo:[1,0,0]
v_pk_fma_f32 v[118:119], v[110:111], v[62:63], v[118:119] op_sel:[1,1,0] op_sel_hi:[0,1,1] neg_lo:[1,0,0]
v_pk_fma_f32 v[104:105], v[112:113], v[62:63], v[104:105] op_sel:[1,1,0] op_sel_hi:[0,1,1] neg_lo:[1,0,0]
v_cvt_pk_bf16_f32 v23, v114, v115
ds_write_addtid_b32 v23 offset:26832
v_cvt_pk_bf16_f32 v24, v116, v117
ds_write_addtid_b32 v24 offset:28896
v_cvt_pk_bf16_f32 v25, v118, v119
ds_write_addtid_b32 v25 offset:30960
v_cvt_pk_bf16_f32 v20, v104, v105
ds_write_addtid_b32 v20 offset:33024
ds_read_b128 v[160:163], v28 offset:0
ds_read_b128 v[164:167], v28 offset:32
ds_read_b128 v[168:171], v28 offset:64
ds_read_b128 v[172:175], v28 offset:96
ds_read_b128 v[176:179], v28 offset:128
ds_read_b128 v[180:183], v28 offset:160
ds_read_b128 v[184:187], v28 offset:192
ds_read_b128 v[188:191], v28 offset:224
v_pk_mul_f32 v[106:107], v[114:115], v[62:63] op_sel:[0,0] op_sel_hi:[1,0]
v_pk_mul_f32 v[108:109], v[116:117], v[62:63] op_sel:[0,0] op_sel_hi:[1,0]
v_pk_mul_f32 v[110:111], v[118:119], v[62:63] op_sel:[0,0] op_sel_hi:[1,0]
v_pk_mul_f32 v[112:113], v[104:105], v[62:63] op_sel:[0,0] op_sel_hi:[1,0]
v_pk_fma_f32 v[106:107], v[114:115], v[62:63], v[106:107] op_sel:[1,1,0] op_sel_hi:[0,1,1] neg_lo:[1,0,0]
v_pk_fma_f32 v[108:109], v[116:117], v[62:63], v[108:109] op_sel:[1,1,0] op_sel_hi:[0,1,1] neg_lo:[1,0,0]
v_pk_fma_f32 v[110:111], v[118:119], v[62:63], v[110:111] op_sel:[1,1,0] op_sel_hi:[0,1,1] neg_lo:[1,0,0]
v_pk_fma_f32 v[112:113], v[104:105], v[62:63], v[112:113] op_sel:[1,1,0] op_sel_hi:[0,1,1] neg_lo:[1,0,0]
v_cvt_pk_bf16_f32 v21, v106, v107
ds_write_addtid_b32 v21 offset:35088
v_cvt_pk_bf16_f32 v22, v108, v109
ds_write_addtid_b32 v22 offset:37152
v_cvt_pk_bf16_f32 v23, v110, v111
ds_write_addtid_b32 v23 offset:39216
v_cvt_pk_bf16_f32 v24, v112, v113
ds_write_addtid_b32 v24 offset:41280
v_pk_mul_f32 v[114:115], v[106:107], v[62:63] op_sel:[0,0] op_sel_hi:[1,0]
v_pk_mul_f32 v[116:117], v[108:109], v[62:63] op_sel:[0,0] op_sel_hi:[1,0]
v_pk_mul_f32 v[118:119], v[110:111], v[62:63] op_sel:[0,0] op_sel_hi:[1,0]
v_pk_mul_f32 v[104:105], v[112:113], v[62:63] op_sel:[0,0] op_sel_hi:[1,0]
v_pk_fma_f32 v[114:115], v[106:107], v[62:63], v[114:115] op_sel:[1,1,0] op_sel_hi:[0,1,1] neg_lo:[1,0,0]
v_pk_fma_f32 v[116:117], v[108:109], v[62:63], v[116:117] op_sel:[1,1,0] op_sel_hi:[0,1,1] neg_lo:[1,0,0]
v_pk_fma_f32 v[118:119], v[110:111], v[62:63], v[118:119] op_sel:[1,1,0] op_sel_hi:[0,1,1] neg_lo:[1,0,0]
v_pk_fma_f32 v[104:105], v[112:113], v[62:63], v[104:105] op_sel:[1,1,0] op_sel_hi:[0,1,1] neg_lo:[1,0,0]
v_cvt_pk_bf16_f32 v25, v114, v115
ds_write_addtid_b32 v25 offset:43344
v_cvt_pk_bf16_f32 v20, v116, v117
ds_write_addtid_b32 v20 offset:45408
v_cvt_pk_bf16_f32 v21, v118, v119
ds_write_addtid_b32 v21 offset:47472
v_cvt_pk_bf16_f32 v22, v104, v105
ds_write_addtid_b32 v22 offset:49536
v_pk_mul_f32 v[106:107], v[114:115], v[62:63] op_sel:[0,0] op_sel_hi:[1,0]
v_pk_mul_f32 v[108:109], v[116:117], v[62:63] op_sel:[0,0] op_sel_hi:[1,0]
v_pk_mul_f32 v[110:111], v[118:119], v[62:63] op_sel:[0,0] op_sel_hi:[1,0]
v_pk_mul_f32 v[112:113], v[104:105], v[62:63] op_sel:[0,0] op_sel_hi:[1,0]
v_pk_fma_f32 v[106:107], v[114:115], v[62:63], v[106:107] op_sel:[1,1,0] op_sel_hi:[0,1,1] neg_lo:[1,0,0]
v_pk_fma_f32 v[108:109], v[116:117], v[62:63], v[108:109] op_sel:[1,1,0] op_sel_hi:[0,1,1] neg_lo:[1,0,0]
v_pk_fma_f32 v[110:111], v[118:119], v[62:63], v[110:111] op_sel:[1,1,0] op_sel_hi:[0,1,1] neg_lo:[1,0,0]
v_pk_fma_f32 v[112:113], v[104:105], v[62:63], v[112:113] op_sel:[1,1,0] op_sel_hi:[0,1,1] neg_lo:[1,0,0]
v_cvt_pk_bf16_f32 v23, v106, v107
ds_write_addtid_b32 v23 offset:51600
v_cvt_pk_bf16_f32 v24, v108, v109
ds_write_addtid_b32 v24 offset:53664
v_cvt_pk_bf16_f32 v25, v110, v111
ds_write_addtid_b32 v25 offset:55728
v_cvt_pk_bf16_f32 v20, v112, v113
ds_write_addtid_b32 v20 offset:57792
v_pk_mul_f32 v[114:115], v[106:107], v[62:63] op_sel:[0,0] op_sel_hi:[1,0]
v_pk_mul_f32 v[116:117], v[108:109], v[62:63] op_sel:[0,0] op_sel_hi:[1,0]
v_pk_mul_f32 v[118:119], v[110:111], v[62:63] op_sel:[0,0] op_sel_hi:[1,0]
v_pk_fma_f32 v[114:115], v[106:107], v[62:63], v[114:115] op_sel:[1,1,0] op_sel_hi:[0,1,1] neg_lo:[1,0,0]
v_pk_fma_f32 v[116:117], v[108:109], v[62:63], v[116:117] op_sel:[1,1,0] op_sel_hi:[0,1,1] neg_lo:[1,0,0]
v_pk_fma_f32 v[118:119], v[110:111], v[62:63], v[118:119] op_sel:[1,1,0] op_sel_hi:[0,1,1] neg_lo:[1,0,0]
v_cvt_pk_bf16_f32 v21, v114, v115
ds_write_addtid_b32 v21 offset:59856
v_cvt_pk_bf16_f32 v22, v116, v117
ds_write_addtid_b32 v22 offset:61920
v_cvt_pk_bf16_f32 v23, v118, v119
ds_write_addtid_b32 v23 offset:63984
s_waitcnt lgkmcnt(0)
ds_read_b128 v[68:71], v27 offset:0
ds_read_b128 v[76:79], v27 offset:32
ds_read_b128 v[84:87], v27 offset:64
ds_read_b128 v[92:95], v27 offset:96
ds_read_b128 v[100:103], v27 offset:128
ds_read_b128 v[108:111], v27 offset:160
ds_read_b128 v[116:119], v27 offset:192
ds_read_b128 v[124:127], v27 offset:224
v_add_u32 v15, 1048576, v6
global_load_dword v4, v15, s[8:9]
v_add_u32 v15, 1572864, v6
global_load_dword v5, v15, s[8:9]
v_mov_b32 v32, s74
v_sub_f32 v34, s76, v32
v_mov_b32 v33, s75
v_sub_f32 v35, s77, v33
s_waitcnt lgkmcnt(7)
v_mfma_f32_32x32x16_bf16 v[128:143], v[160:163], v[68:71], 0
s_waitcnt lgkmcnt(6)
v_mfma_f32_32x32x16_bf16 v[128:143], v[164:167], v[76:79], v[128:143]
s_waitcnt lgkmcnt(5)
v_mfma_f32_32x32x16_bf16 v[128:143], v[168:171], v[84:87], v[128:143]
s_waitcnt lgkmcnt(4)
v_mfma_f32_32x32x16_bf16 v[128:143], v[172:175], v[92:95], v[128:143]
s_waitcnt lgkmcnt(3)
v_mfma_f32_32x32x16_bf16 v[128:143], v[176:179], v[100:103], v[128:143]
s_waitcnt lgkmcnt(2)
v_mfma_f32_32x32x16_bf16 v[128:143], v[180:183], v[108:111], v[128:143]
s_waitcnt lgkmcnt(1)
v_mfma_f32_32x32x16_bf16 v[128:143], v[184:187], v[116:119], v[128:143]
s_waitcnt lgkmcnt(0)
v_mfma_f32_32x32x16_bf16 v[128:143], v[188:191], v[124:127], v[128:143]
s_waitcnt vmcnt(2)
ds_write_b16 v7, v2 offset:0
ds_write_b16_d16_hi v7, v2 offset:4672
ds_write_b16 v7, v3 offset:1024
ds_write_b16_d16_hi v7, v3 offset:5696
s_nop 7
s_nop 3
ds_write_b128 v29, v[128:131] offset:0
ds_write_b128 v29, v[132:135] offset:8256
ds_write_b128 v29, v[136:139] offset:16512
s_waitcnt lgkmcnt(0)
s_barrier
ds_read_b128 v[64:67], v30 offset:0
ds_read_b128 v[68:71], v30 offset:8256
ds_read_b128 v[72:75], v30 offset:16512
s_bitcmp1_b32 s52, 0
s_cbranch_scc1 L_pre_odd
s_lshl_b32 s56, s52, 7
v_subrev_u32 v24, s56, v10
ds_read_b128 v[176:179], v24 offset:544
ds_read_b128 v[180:183], v24 offset:480
ds_read_b128 v[184:187], v24 offset:416
ds_read_b128 v[188:191], v24 offset:352
ds_read_b128 v[144:147], v24 offset:1056
ds_read_b128 v[148:151], v24 offset:992
ds_read_b128 v[152:155], v24 offset:928
ds_read_b128 v[156:159], v24 offset:864
ds_read_b128 v[160:163], v10 offset:32
s_waitcnt lgkmcnt(9)
s_branch L_pre_done
L_pre_odd:
s_cmp_eq_u32 s52, 1
s_cbranch_scc0 L_pre3
ds_read_b128 v[112:115], v10 offset:48
ds_read_b128 v[116:119], v10 offset:64
ds_read_b128 v[120:123], v10 offset:560
ds_read_b128 v[124:127], v10 offset:576
s_waitcnt lgkmcnt(4)
s_branch L_pre_done
L_pre3:
ds_read_b128 v[48:51], v10 offset:48
ds_read_b128 v[52:55], v10 offset:64
ds_read_b128 v[56:59], v10 offset:560
ds_read_b128 v[60:63], v10 offset:576
ds_read_b128 v[168:171], v10 offset:32
ds_read_b128 v[176:179], v10 offset:96
s_waitcnt lgkmcnt(6)
L_pre_done:
v_pk_add_f32 v[64:65], v[64:65], v[128:129]
v_pk_add_f32 v[66:67], v[66:67], v[130:131]
v_pk_add_f32 v[68:69], v[68:69], v[132:133]
v_pk_add_f32 v[70:71], v[70:71], v[134:135]
v_pk_add_f32 v[72:73], v[72:73], v[136:137]
v_pk_add_f32 v[74:75], v[74:75], v[138:139]
s_cmp_eq_u32 s51, 0
v_mov_b32_dpp v76, v68 wave_shl:1 row_mask:0xf bank_mask:0xf
s_cbranch_scc0 L_kb1
v_readlane_b32 s56, v72, 0
v_cvt_pk_bf16_f32 v80, v67, v64
v_cvt_pk_bf16_f32 v81, v66, v65
v_cvt_pk_bf16_f32 v82, v76, v68
v_cvt_pk_bf16_f32 v83, v71, v70
v_cvt_pk_bf16_f32 v84, v70, v70
v_cvt_pk_bf16_f32 v85, v69, v68
v_cvt_pk_bf16_f32 v86, v68, v68
ds_write_b16 v31, v80 offset:1082
ds_write_b32 v31, v81 offset:1084
ds_write_b16_d16_hi v31, v80 offset:1088
s_mov_b32 exec_hi, 0
ds_write_b16 v16, v82 offset:562
ds_write2_b32 v16, v83, v84 offset0:141 offset1:142
ds_write_b32 v16, v85 offset:572
ds_write_b16_d16_hi v16, v82 offset:576
s_mov_b32 exec_lo, 0
s_mov_b32 exec_hi, 1
ds_write_b32 v16, v86 offset:60
ds_write_b16 v16, v86 offset:64
v_mov_b32 v68, 0
s_mov_b32 exec_hi, 0x80000000
v_subrev_f32 v71, s56, v71
s_mov_b32 exec_hi, -1
v_cvt_pk_bf16_f32 v82, v68, v69
v_cvt_pk_bf16_f32 v83, v70, v71
ds_write_b16 v17, v82 offset:2712
ds_write_b16_d16_hi v17, v82 offset:2710
ds_write_b16 v17, v83 offset:2584
ds_write_b16_d16_hi v17, v83 offset:2582
s_branch L_kb2
L_kb1:
v_cvt_pk_bf16_f32 v80, v67, v66
v_cvt_pk_bf16_f32 v81, v65, v64
v_cvt_pk_bf16_f32 v84, v76, v71
v_cvt_pk_bf16_f32 v85, v70, v70
v_cvt_pk_bf16_f32 v86, v70, v69
v_cvt_pk_bf16_f32 v87, v68, v68
v_cvt_pk_bf16_f32 v82, v72, v73
v_cvt_pk_bf16_f32 v83, v74, v75
ds_write_b64 v31, v[80:81] offset:2296
s_mov_b32 exec_hi, 0
ds_write_b128 v16, v[84:87] offset:1776
ds_write_b16 v18, v82 offset:3164
ds_write_b16_d16_hi v18, v82 offset:3100
ds_write_b16 v18, v83 offset:3036
ds_write_b16_d16_hi v18, v83 offset:2972
s_mov_b32 exec_lo, 0
s_mov_b32 exec_hi, 1
ds_write_b16 v16, v87 offset:1274
ds_write_b32 v16, v87 offset:1276
ds_write_b16 v16, v82 offset:2908
L_kb2:
s_mov_b64 exec, -1
s_bitcmp1_b32 s52, 0
s_cbranch_scc0 L_nopoll
global_load_dwordx4 v[224:227], v38, s[46:47] offset:0 sc1
global_load_dwordx4 v[228:231], v38, s[46:47] offset:1024 sc1
L_nopoll:
s_waitcnt lgkmcnt(0)
s_barrier
s_cmp_eq_u32 s52, 1
s_cbranch_scc1 L_role1
s_cmp_eq_u32 s52, 2
s_cbranch_scc1 L_role2
s_cmp_eq_u32 s52, 3
s_cbranch_scc1 L_role3
ds_read2_b32 v[64:65], v13 offset0:176 offset1:177
ds_read2_b32 v[66:67], v13 offset0:178 offset1:179
ds_read2_b32 v[68:69], v14 offset0:176 offset1:177
ds_read2_b32 v[70:71], v14 offset0:178 offset1:179
ds_read2_b32 v[72:73], v13 offset0:160 offset1:161
ds_read2_b32 v[74:75], v13 offset0:162 offset1:163
ds_read2_b32 v[76:77], v14 offset0:160 offset1:161
ds_read2_b32 v[78:79], v14 offset0:162 offset1:163
ds_read2_b32 v[80:81], v13 offset0:144 offset1:145
ds_read2_b32 v[82:83], v13 offset0:146 offset1:147
ds_read2_b32 v[84:85], v14 offset0:144 offset1:145
ds_read2_b32 v[86:87], v14 offset0:146 offset1:147
ds_read2_b32 v[88:89], v13 offset0:128 offset1:129
ds_read2_b32 v[90:91], v13 offset0:130 offset1:131
ds_read2_b32 v[92:93], v14 offset0:128 offset1:129
ds_read2_b32 v[94:95], v14 offset0:130 offset1:131
ds_read2_b32 v[96:97], v13 offset0:48 offset1:49
ds_read2_b32 v[98:99], v13 offset0:50 offset1:51
ds_read2_b32 v[100:101], v14 offset0:48 offset1:49
ds_read2_b32 v[102:103], v14 offset0:50 offset1:51
ds_read2_b32 v[104:105], v13 offset0:32 offset1:33
ds_read2_b32 v[106:107], v13 offset0:34 offset1:35
ds_read2_b32 v[108:109], v14 offset0:32 offset1:33
ds_read2_b32 v[110:111], v14 offset0:34 offset1:35
ds_read2_b32 v[112:113], v13 offset0:16 offset1:17
ds_read2_b32 v[114:115], v13 offset0:18 offset1:19
ds_read2_b32 v[116:117], v14 offset0:16 offset1:17
ds_read2_b32 v[118:119], v14 offset0:18 offset1:19
ds_read2_b32 v[120:121], v13 offset0:0 offset1:1
ds_read2_b32 v[122:123], v13 offset0:2 offset1:3
ds_read2_b32 v[124:125], v14 offset0:0 offset1:1
ds_read2_b32 v[126:127], v14 offset0:2 offset1:3
s_waitcnt lgkmcnt(15)
v_mfma_f32_16x16x32_bf16 v[128:131], v[64:67], v[176:179], 0
v_mfma_f32_16x16x32_bf16 v[132:135], v[68:71], v[176:179], 0
v_mfma_f32_16x16x32_bf16 v[128:131], v[72:75], v[180:183], v[128:131]
v_mfma_f32_16x16x32_bf16 v[132:135], v[76:79], v[180:183], v[132:135]
v_mfma_f32_16x16x32_bf16 v[128:131], v[80:83], v[184:187], v[128:131]
v_mfma_f32_16x16x32_bf16 v[132:135], v[84:87], v[184:187], v[132:135]
v_mfma_f32_16x16x32_bf16 v[128:131], v[88:91], v[188:191], v[128:131]
v_mfma_f32_16x16x32_bf16 v[132:135], v[92:95], v[188:191], v[132:135]
ds_read_b128 v[208:211], v10 offset:1568
ds_read_b128 v[212:215], v10 offset:1504
ds_read_b128 v[216:219], v10 offset:1440
ds_read_b128 v[220:223], v10 offset:1376
v_mfma_f32_16x16x32_bf16 v[136:139], v[64:67], v[144:147], 0
v_mfma_f32_16x16x32_bf16 v[140:143], v[68:71], v[144:147], 0
s_waitcnt lgkmcnt(15)
v_mfma_f32_16x16x32_bf16 v[136:139], v[96:99], v[176:179], v[136:139]
v_mfma_f32_16x16x32_bf16 v[140:143], v[100:103], v[176:179], v[140:143]
v_mfma_f32_16x16x32_bf16 v[136:139], v[72:75], v[148:151], v[136:139]
v_mfma_f32_16x16x32_bf16 v[140:143], v[76:79], v[148:151], v[140:143]
s_waitcnt lgkmcnt(12)
v_mfma_f32_16x16x32_bf16 v[136:139], v[104:107], v[180:183], v[136:139]
v_mfma_f32_16x16x32_bf16 v[140:143], v[108:111], v[180:183], v[140:143]
v_mfma_f32_16x16x32_bf16 v[136:139], v[80:83], v[152:155], v[136:139]
v_mfma_f32_16x16x32_bf16 v[140:143], v[84:87], v[152:155], v[140:143]
s_waitcnt lgkmcnt(8)
v_mfma_f32_16x16x32_bf16 v[136:139], v[112:115], v[184:187], v[136:139]
v_mfma_f32_16x16x32_bf16 v[140:143], v[116:119], v[184:187], v[140:143]
v_mfma_f32_16x16x32_bf16 v[136:139], v[88:91], v[156:159], v[136:139]
v_mfma_f32_16x16x32_bf16 v[140:143], v[92:95], v[156:159], v[140:143]
s_waitcnt lgkmcnt(4)
v_mfma_f32_16x16x32_bf16 v[136:139], v[120:123], v[188:191], v[136:139]
v_mfma_f32_16x16x32_bf16 v[140:143], v[124:127], v[188:191], v[140:143]
v_mfma_f32_16x16x32_bf16 v[128:131], v[96:99], v[160:163], v[128:131]
v_mfma_f32_16x16x32_bf16 v[132:135], v[100:103], v[160:163], v[132:135]
s_waitcnt vmcnt(0)
ds_write_b16 v7, v4 offset:2048
ds_write_b16_d16_hi v7, v4 offset:6720
ds_write_b16 v7, v5 offset:3072
ds_write_b16_d16_hi v7, v5 offset:7744
s_waitcnt lgkmcnt(0)
s_barrier
ds_read_b128 v[40:43], v12 offset:0
ds_read_b128 v[44:47], v12 offset:1024
s_or_b32 s56, s2, s48
s_cmp_eq_u32 s56, 0
s_cbranch_scc0 L_noe
v_mov_b32 v24, 0x4000
v_mov_b32 v25, s3
s_mov_b64 exec, 1
global_store_dword v24, v25, s[46:47]
s_mov_b64 exec, -1
L_noe:
v_mfma_f32_16x16x32_bf16 v[224:227], v[96:99], v[144:147], 0
v_mfma_f32_16x16x32_bf16 v[228:231], v[100:103], v[144:147], 0
v_mfma_f32_16x16x32_bf16 v[224:227], v[104:107], v[148:151], v[224:227]
v_mfma_f32_16x16x32_bf16 v[228:231], v[108:111], v[148:151], v[228:231]
s_waitcnt lgkmcnt(0)
v_pk_add_f32 v[128:129], v[128:129], v[132:133] neg_lo:[0,1] neg_hi:[0,1]
v_pk_add_f32 v[130:131], v[130:131], v[134:135] neg_lo:[0,1] neg_hi:[0,1]
v_pk_fma_f32 v[128:129], v[40:41], v[128:129], v[132:133]
v_pk_fma_f32 v[130:131], v[42:43], v[130:131], v[134:135]
ds_write_b128 v11, v[128:131] offset:0
v_pk_add_f32 v[136:137], v[136:137], v[140:141] neg_lo:[0,1] neg_hi:[0,1]
v_pk_add_f32 v[138:139], v[138:139], v[142:143] neg_lo:[0,1] neg_hi:[0,1]
v_pk_fma_f32 v[136:137], v[44:45], v[136:137], v[140:141]
v_pk_fma_f32 v[138:139], v[46:47], v[138:139], v[142:143]
ds_write_b128 v11, v[136:139] offset:1024
ds_read_b128 v[40:43], v12 offset:2048
ds_read_b128 v[44:47], v12 offset:3072
v_mfma_f32_16x16x32_bf16 v[224:227], v[112:115], v[152:155], v[224:227]
v_mfma_f32_16x16x32_bf16 v[228:231], v[116:119], v[152:155], v[228:231]
v_mfma_f32_16x16x32_bf16 v[224:227], v[120:123], v[156:159], v[224:227]
v_mfma_f32_16x16x32_bf16 v[228:231], v[124:127], v[156:159], v[228:231]
ds_read_b128 v[160:163], v10 offset:2080
ds_read_b128 v[164:167], v10 offset:2016
ds_read_b128 v[168:171], v10 offset:1952
ds_read_b128 v[172:175], v10 offset:1888
v_mfma_f32_16x16x32_bf16 v[224:227], v[64:67], v[208:211], v[224:227]
v_mfma_f32_16x16x32_bf16 v[228:231], v[68:71], v[208:211], v[228:231]
s_waitcnt lgkmcnt(0)
s_barrier
ds_read2st64_b32 v[20:21], v8 offset0:0 offset1:32
ds_read2st64_b32 v[22:23], v8 offset0:8 offset1:40
ds_read2st64_b32 v[24:25], v8 offset0:16 offset1:48
ds_read2st64_b32 v[26:27], v8 offset0:24 offset1:56
ds_read_b32 v28, v9 offset:0
v_mfma_f32_16x16x32_bf16 v[232:235], v[96:99], v[208:211], 0
v_mfma_f32_16x16x32_bf16 v[236:239], v[100:103], v[208:211], 0
v_mfma_f32_16x16x32_bf16 v[224:227], v[72:75], v[212:215], v[224:227]
v_mfma_f32_16x16x32_bf16 v[228:231], v[76:79], v[212:215], v[228:231]
v_lshlrev_b32 v30, 16, v2
v_and_b32 v31, 0xffff0000, v2
s_waitcnt lgkmcnt(0)
v_pk_add_f32 v[20:21], v[20:21], v[22:23]
v_pk_add_f32 v[24:25], v[24:25], v[26:27]
v_pk_fma_f32 v[28:29], v[28:29], v[34:35], v[32:33] op_sel_hi:[0,1,1]
v_pk_add_f32 v[20:21], v[20:21], v[24:25]
v_pk_fma_f32 v[20:21], v[30:31], v[28:29], v[20:21]
v_cvt_pk_bf16_f32 v20, v20, v21
global_store_dword v6, v20, s[42:43]
L_hs00:
v_mfma_f32_16x16x32_bf16 v[232:235], v[104:107], v[212:215], v[232:235]
v_mfma_f32_16x16x32_bf16 v[236:239], v[108:111], v[212:215], v[236:239]
v_mfma_f32_16x16x32_bf16 v[224:227], v[80:83], v[216:219], v[224:227]
v_mfma_f32_16x16x32_bf16 v[228:231], v[84:87], v[216:219], v[228:231]
v_mfma_f32_16x16x32_bf16 v[232:235], v[112:115], v[216:219], v[232:235]
v_mfma_f32_16x16x32_bf16 v[236:239], v[116:119], v[216:219], v[236:239]
v_mfma_f32_16x16x32_bf16 v[224:227], v[88:91], v[220:223], v[224:227]
v_mfma_f32_16x16x32_bf16 v[228:231], v[92:95], v[220:223], v[228:231]
v_mfma_f32_16x16x32_bf16 v[232:235], v[120:123], v[220:223], v[232:235]
v_mfma_f32_16x16x32_bf16 v[236:239], v[124:127], v[220:223], v[236:239]
ds_read_b128 v[176:179], v10 offset:2592
ds_read_b128 v[180:183], v10 offset:2528
ds_read_b128 v[184:187], v10 offset:2464
ds_read_b128 v[188:191], v10 offset:2400
v_mfma_f32_16x16x32_bf16 v[232:235], v[64:67], v[160:163], v[232:235]
v_mfma_f32_16x16x32_bf16 v[236:239], v[68:71], v[160:163], v[236:239]
v_mfma_f32_16x16x32_bf16 v[232:235], v[72:75], v[164:167], v[232:235]
v_mfma_f32_16x16x32_bf16 v[236:239], v[76:79], v[164:167], v[236:239]
v_mfma_f32_16x16x32_bf16 v[232:235], v[80:83], v[168:171], v[232:235]
v_mfma_f32_16x16x32_bf16 v[236:239], v[84:87], v[168:171], v[236:239]
v_mfma_f32_16x16x32_bf16 v[232:235], v[88:91], v[172:175], v[232:235]
v_mfma_f32_16x16x32_bf16 v[236:239], v[92:95], v[172:175], v[236:239]
v_mfma_f32_16x16x32_bf16 v[128:131], v[96:99], v[160:163], 0
v_mfma_f32_16x16x32_bf16 v[132:135], v[100:103], v[160:163], 0
v_mfma_f32_16x16x32_bf16 v[128:131], v[104:107], v[164:167], v[128:131]
v_mfma_f32_16x16x32_bf16 v[132:135], v[108:111], v[164:167], v[132:135]
v_pk_add_f32 v[224:225], v[224:225], v[228:229] neg_lo:[0,1] neg_hi:[0,1]
v_pk_add_f32 v[226:227], v[226:227], v[230:231] neg_lo:[0,1] neg_hi:[0,1]
v_pk_fma_f32 v[224:225], v[40:41], v[224:225], v[228:229]
v_pk_fma_f32 v[226:227], v[42:43], v[226:227], v[230:231]
ds_write_b128 v11, v[224:227] offset:16384
v_pk_add_f32 v[232:233], v[232:233], v[236:237] neg_lo:[0,1] neg_hi:[0,1]
v_pk_add_f32 v[234:235], v[234:235], v[238:239] neg_lo:[0,1] neg_hi:[0,1]
v_pk_fma_f32 v[232:233], v[44:45], v[232:233], v[236:237]
v_pk_fma_f32 v[234:235], v[46:47], v[234:235], v[238:239]
ds_write_b128 v11, v[232:235] offset:17408
ds_read_b128 v[40:43], v12 offset:4096
ds_read_b128 v[44:47], v12 offset:5120
v_mfma_f32_16x16x32_bf16 v[128:131], v[112:115], v[168:171], v[128:131]
v_mfma_f32_16x16x32_bf16 v[132:135], v[116:119], v[168:171], v[132:135]
v_mfma_f32_16x16x32_bf16 v[128:131], v[120:123], v[172:175], v[128:131]
v_mfma_f32_16x16x32_bf16 v[132:135], v[124:127], v[172:175], v[132:135]
ds_read_b128 v[144:147], v10 offset:3104
ds_read_b128 v[148:151], v10 offset:3040
ds_read_b128 v[152:155], v10 offset:2976
ds_read_b128 v[156:159], v10 offset:2912
s_waitcnt lgkmcnt(11)
v_mfma_f32_16x16x32_bf16 v[128:131], v[64:67], v[176:179], v[128:131]
v_mfma_f32_16x16x32_bf16 v[132:135], v[68:71], v[176:179], v[132:135]
s_waitcnt lgkmcnt(0)
s_barrier
ds_read2st64_b32 v[20:21], v8 offset0:64 offset1:96
ds_read2st64_b32 v[22:23], v8 offset0:72 offset1:104
ds_read2st64_b32 v[24:25], v8 offset0:80 offset1:112
ds_read2st64_b32 v[26:27], v8 offset0:88 offset1:120
ds_read_b32 v28, v9 offset:2048
v_mfma_f32_16x16x32_bf16 v[136:139], v[96:99], v[176:179], 0
v_mfma_f32_16x16x32_bf16 v[140:143], v[100:103], v[176:179], 0
v_mfma_f32_16x16x32_bf16 v[128:131], v[72:75], v[180:183], v[128:131]
v_mfma_f32_16x16x32_bf16 v[132:135], v[76:79], v[180:183], v[132:135]
v_lshlrev_b32 v30, 16, v3
v_and_b32 v31, 0xffff0000, v3
v_add_u32 v15, 524288, v6
s_waitcnt lgkmcnt(0)
v_pk_add_f32 v[20:21], v[20:21], v[22:23]
v_pk_add_f32 v[24:25], v[24:25], v[26:27]
v_pk_fma_f32 v[28:29], v[28:29], v[34:35], v[32:33] op_sel_hi:[0,1,1]
v_pk_add_f32 v[20:21], v[20:21], v[24:25]
v_pk_fma_f32 v[20:21], v[30:31], v[28:29], v[20:21]
v_cvt_pk_bf16_f32 v20, v20, v21
global_store_dword v15, v20, s[42:43]
L_hs01:
v_mfma_f32_16x16x32_bf16 v[136:139], v[104:107], v[180:183], v[136:139]
v_mfma_f32_16x16x32_bf16 v[140:143], v[108:111], v[180:183], v[140:143]
v_mfma_f32_16x16x32_bf16 v[128:131], v[80:83], v[184:187], v[128:131]
v_mfma_f32_16x16x32_bf16 v[132:135], v[84:87], v[184:187], v[132:135]
v_mfma_f32_16x16x32_bf16 v[136:139], v[112:115], v[184:187], v[136:139]
v_mfma_f32_16x16x32_bf16 v[140:143], v[116:119], v[184:187], v[140:143]
v_mfma_f32_16x16x32_bf16 v[128:131], v[88:91], v[188:191], v[128:131]
v_mfma_f32_16x16x32_bf16 v[132:135], v[92:95], v[188:191], v[132:135]
v_mfma_f32_16x16x32_bf16 v[136:139], v[120:123], v[188:191], v[136:139]
v_mfma_f32_16x16x32_bf16 v[140:143], v[124:127], v[188:191], v[140:143]
ds_read_b128 v[208:211], v10 offset:3616
ds_read_b128 v[212:215], v10 offset:3552
ds_read_b128 v[216:219], v10 offset:3488
ds_read_b128 v[220:223], v10 offset:3424
v_mfma_f32_16x16x32_bf16 v[136:139], v[64:67], v[144:147], v[136:139]
v_mfma_f32_16x16x32_bf16 v[140:143], v[68:71], v[144:147], v[140:143]
v_mfma_f32_16x16x32_bf16 v[136:139], v[72:75], v[148:151], v[136:139]
v_mfma_f32_16x16x32_bf16 v[140:143], v[76:79], v[148:151], v[140:143]
v_mfma_f32_16x16x32_bf16 v[136:139], v[80:83], v[152:155], v[136:139]
v_mfma_f32_16x16x32_bf16 v[140:143], v[84:87], v[152:155], v[140:143]
v_mfma_f32_16x16x32_bf16 v[136:139], v[88:91], v[156:159], v[136:139]
v_mfma_f32_16x16x32_bf16 v[140:143], v[92:95], v[156:159], v[140:143]
v_mfma_f32_16x16x32_bf16 v[224:227], v[96:99], v[144:147], 0
v_mfma_f32_16x16x32_bf16 v[228:231], v[100:103], v[144:147], 0
v_mfma_f32_16x16x32_bf16 v[224:227], v[104:107], v[148:151], v[224:227]
v_mfma_f32_16x16x32_bf16 v[228:231], v[108:111], v[148:151], v[228:231]
v_pk_add_f32 v[128:129], v[128:129], v[132:133] neg_lo:[0,1] neg_hi:[0,1]
v_pk_add_f32 v[130:131], v[130:131], v[134:135] neg_lo:[0,1] neg_hi:[0,1]
v_pk_fma_f32 v[128:129], v[40:41], v[128:129], v[132:133]
v_pk_fma_f32 v[130:131], v[42:43], v[130:131], v[134:135]
ds_write_b128 v11, v[128:131] offset:32768
v_pk_add_f32 v[136:137], v[136:137], v[140:141] neg_lo:[0,1] neg_hi:[0,1]
v_pk_add_f32 v[138:139], v[138:139], v[142:143] neg_lo:[0,1] neg_hi:[0,1]
v_pk_fma_f32 v[136:137], v[44:45], v[136:137], v[140:141]
v_pk_fma_f32 v[138:139], v[46:47], v[138:139], v[142:143]
ds_write_b128 v11, v[136:139] offset:33792
ds_read_b128 v[40:43], v12 offset:6144
ds_read_b128 v[44:47], v12 offset:7168
v_mfma_f32_16x16x32_bf16 v[224:227], v[112:115], v[152:155], v[224:227]
v_mfma_f32_16x16x32_bf16 v[228:231], v[116:119], v[152:155], v[228:231]
v_mfma_f32_16x16x32_bf16 v[224:227], v[120:123], v[156:159], v[224:227]
v_mfma_f32_16x16x32_bf16 v[228:231], v[124:127], v[156:159], v[228:231]
ds_read_b128 v[160:163], v10 offset:4128
ds_read_b128 v[164:167], v10 offset:4064
ds_read_b128 v[168:171], v10 offset:4000
ds_read_b128 v[172:175], v10 offset:3936
s_waitcnt lgkmcnt(11)
v_mfma_f32_16x16x32_bf16 v[224:227], v[64:67], v[208:211], v[224:227]
v_mfma_f32_16x16x32_bf16 v[228:231], v[68:71], v[208:211], v[228:231]
s_waitcnt lgkmcnt(0)
s_barrier
ds_read2st64_b32 v[20:21], v8 offset0:128 offset1:160
ds_read2st64_b32 v[22:23], v8 offset0:136 offset1:168
ds_read2st64_b32 v[24:25], v8 offset0:144 offset1:176
ds_read2st64_b32 v[26:27], v8 offset0:152 offset1:184
ds_read_b32 v28, v9 offset:4096
v_mfma_f32_16x16x32_bf16 v[232:235], v[96:99], v[208:211], 0
v_mfma_f32_16x16x32_bf16 v[236:239], v[100:103], v[208:211], 0
v_mfma_f32_16x16x32_bf16 v[224:227], v[72:75], v[212:215], v[224:227]
v_mfma_f32_16x16x32_bf16 v[228:231], v[76:79], v[212:215], v[228:231]
v_lshlrev_b32 v30, 16, v4
v_and_b32 v31, 0xffff0000, v4
v_add_u32 v15, 1048576, v6
s_waitcnt lgkmcnt(0)
v_pk_add_f32 v[20:21], v[20:21], v[22:23]
v_pk_add_f32 v[24:25], v[24:25], v[26:27]
v_pk_fma_f32 v[28:29], v[28:29], v[34:35], v[32:33] op_sel_hi:[0,1,1]
v_pk_add_f32 v[20:21], v[20:21], v[24:25]
v_pk_fma_f32 v[20:21], v[30:31], v[28:29], v[20:21]
v_cvt_pk_bf16_f32 v20, v20, v21
global_store_dword v15, v20, s[42:43]
L_hs02:
v_mfma_f32_16x16x32_bf16 v[232:235], v[104:107], v[212:215], v[232:235]
v_mfma_f32_16x16x32_bf16 v[236:239], v[108:111], v[212:215], v[236:239]
v_mfma_f32_16x16x32_bf16 v[224:227], v[80:83], v[216:219], v[224:227]
v_mfma_f32_16x16x32_bf16 v[228:231], v[84:87], v[216:219], v[228:231]
v_mfma_f32_16x16x32_bf16 v[232:235], v[112:115], v[216:219], v[232:235]
v_mfma_f32_16x16x32_bf16 v[236:239], v[116:119], v[216:219], v[236:239]
v_mfma_f32_16x16x32_bf16 v[224:227], v[88:91], v[220:223], v[224:227]
v_mfma_f32_16x16x32_bf16 v[228:231], v[92:95], v[220:223], v[228:231]
v_mfma_f32_16x16x32_bf16 v[232:235], v[120:123], v[220:223], v[232:235]
v_mfma_f32_16x16x32_bf16 v[236:239], v[124:127], v[220:223], v[236:239]
v_mfma_f32_16x16x32_bf16 v[232:235], v[64:67], v[160:163], v[232:235]
v_mfma_f32_16x16x32_bf16 v[236:239], v[68:71], v[160:163], v[236:239]
v_mfma_f32_16x16x32_bf16 v[232:235], v[72:75], v[164:167], v[232:235]
v_mfma_f32_16x16x32_bf16 v[236:239], v[76:79], v[164:167], v[236:239]
v_mfma_f32_16x16x32_bf16 v[232:235], v[80:83], v[168:171], v[232:235]
v_mfma_f32_16x16x32_bf16 v[236:239], v[84:87], v[168:171], v[236:239]
v_mfma_f32_16x16x32_bf16 v[232:235], v[88:91], v[172:175], v[232:235]
v_mfma_f32_16x16x32_bf16 v[236:239], v[92:95], v[172:175], v[236:239]
s_nop 7
v_pk_add_f32 v[224:225], v[224:225], v[228:229] neg_lo:[0,1] neg_hi:[0,1]
v_pk_add_f32 v[226:227], v[226:227], v[230:231] neg_lo:[0,1] neg_hi:[0,1]
v_pk_fma_f32 v[224:225], v[40:41], v[224:225], v[228:229]
v_pk_fma_f32 v[226:227], v[42:43], v[226:227], v[230:231]
ds_write_b128 v11, v[224:227] offset:49152
v_pk_add_f32 v[232:233], v[232:233], v[236:237] neg_lo:[0,1] neg_hi:[0,1]
v_pk_add_f32 v[234:235], v[234:235], v[238:239] neg_lo:[0,1] neg_hi:[0,1]
v_pk_fma_f32 v[232:233], v[44:45], v[232:233], v[236:237]
v_pk_fma_f32 v[234:235], v[46:47], v[234:235], v[238:239]
ds_write_b128 v11, v[232:235] offset:50176
s_waitcnt lgkmcnt(0)
s_barrier
ds_read2st64_b32 v[20:21], v8 offset0:192 offset1:224
ds_read2st64_b32 v[22:23], v8 offset0:200 offset1:232
ds_read2st64_b32 v[24:25], v8 offset0:208 offset1:240
ds_read2st64_b32 v[26:27], v8 offset0:216 offset1:248
ds_read_b32 v28, v9 offset:6144
v_lshlrev_b32 v30, 16, v5
v_and_b32 v31, 0xffff0000, v5
v_add_u32 v15, 1572864, v6
s_waitcnt lgkmcnt(0)
v_pk_add_f32 v[20:21], v[20:21], v[22:23]
v_pk_add_f32 v[24:25], v[24:25], v[26:27]
v_pk_fma_f32 v[28:29], v[28:29], v[34:35], v[32:33] op_sel_hi:[0,1,1]
v_pk_add_f32 v[20:21], v[20:21], v[24:25]
v_pk_fma_f32 v[20:21], v[30:31], v[28:29], v[20:21]
v_cvt_pk_bf16_f32 v20, v20, v21
global_store_dword v15, v20, s[42:43]
L_hs03:
s_branch L_fin
L_role1:
s_setprio 2
s_mov_b32 s57, 31
s_mov_b32 s73, 16256
v_add_u32 v24, 15, v19
v_med3_i32 v24, v24, 0, 17
v_lshlrev_b32 v24, v24, s57
v_bfe_u32 v192, v24, 9, 2
v_bfe_u32 v193, v24, 11, 2
v_bfe_u32 v194, v24, 13, 2
v_bfe_u32 v195, v24, 15, 2
v_mul_u32_u24 v192, 0x8001, v192
v_mul_u32_u24 v193, 0x8001, v193
v_mul_u32_u24 v194, 0x8001, v194
v_mul_u32_u24 v195, 0x8001, v195
v_and_b32 v192, 0x10001, v192
v_and_b32 v193, 0x10001, v193
v_and_b32 v194, 0x10001, v194
v_and_b32 v195, 0x10001, v195
v_mul_u32_u24 v192, s73, v192
v_mul_u32_u24 v193, s73, v193
v_mul_u32_u24 v194, s73, v194
v_mul_u32_u24 v195, s73, v195
s_mov_b32 s57, 7
s_mov_b32 s73, 16256
v_add_u32 v24, 20, v19
v_med3_i32 v24, v24, 0, 17
v_lshlrev_b32 v24, v24, s57
v_bfe_u32 v196, v24, 9, 2
v_bfe_u32 v197, v24, 11, 2
v_bfe_u32 v198, v24, 13, 2
v_bfe_u32 v199, v24, 15, 2
v_mul_u32_u24 v196, 0x8001, v196
v_mul_u32_u24 v197, 0x8001, v197
v_mul_u32_u24 v198, 0x8001, v198
v_mul_u32_u24 v199, 0x8001, v199
v_and_b32 v196, 0x10001, v196
v_and_b32 v197, 0x10001, v197
v_and_b32 v198, 0x10001, v198
v_and_b32 v199, 0x10001, v199
v_mul_u32_u24 v196, s73, v196
v_mul_u32_u24 v197, s73, v197
v_mul_u32_u24 v198, s73, v198
v_mul_u32_u24 v199, s73, v199
v_mfma_f32_16x16x32_bf16 v[208:211], v[112:115], v[192:195], 0
v_mfma_f32_16x16x32_bf16 v[212:215], v[112:115], v[196:199], 0
v_mfma_f32_16x16x32_bf16 v[216:219], v[116:119], v[192:195], 0
v_mfma_f32_16x16x32_bf16 v[220:223], v[116:119], v[196:199], 0
s_nop 7
v_cvt_pk_bf16_f32 v48, v208, v212
v_cvt_pk_bf16_f32 v49, v216, v220
v_cvt_pk_bf16_f32 v50, v209, v213
v_cvt_pk_bf16_f32 v51, v217, v221
v_cvt_pk_bf16_f32 v52, v210, v214
v_cvt_pk_bf16_f32 v53, v218, v222
v_cvt_pk_bf16_f32 v54, v211, v215
v_cvt_pk_bf16_f32 v55, v219, v223
ds_write_b128 v36, v[48:51] offset:0
ds_write_b128 v36, v[52:55] offset:16
ds_read_b128 v[188:191], v37 offset:64
v_mfma_f32_16x16x32_bf16 v[208:211], v[120:123], v[192:195], 0
v_mfma_f32_16x16x32_bf16 v[212:215], v[120:123], v[196:199], 0
v_mfma_f32_16x16x32_bf16 v[216:219], v[124:127], v[192:195], 0
v_mfma_f32_16x16x32_bf16 v[220:223], v[124:127], v[196:199], 0
ds_read_b128 v[112:115], v10 offset:1072
ds_read_b128 v[116:119], v10 offset:1088
s_nop 7
v_cvt_pk_bf16_f32 v48, v208, v212
v_cvt_pk_bf16_f32 v49, v216, v220
v_cvt_pk_bf16_f32 v50, v209, v213
v_cvt_pk_bf16_f32 v51, v217, v221
v_cvt_pk_bf16_f32 v52, v210, v214
v_cvt_pk_bf16_f32 v53, v218, v222
v_cvt_pk_bf16_f32 v54, v211, v215
v_cvt_pk_bf16_f32 v55, v219, v223
ds_write_b128 v36, v[48:51] offset:128
ds_write_b128 v36, v[52:55] offset:144
ds_read_b128 v[144:147], v37 offset:128
ds_read_b128 v[148:151], v37 offset:192
s_waitcnt lgkmcnt(4)
v_mfma_f32_16x16x32_bf16 v[208:211], v[112:115], v[192:195], 0
v_mfma_f32_16x16x32_bf16 v[212:215], v[112:115], v[196:199], 0
v_mfma_f32_16x16x32_bf16 v[216:219], v[116:119], v[192:195], 0
v_mfma_f32_16x16x32_bf16 v[220:223], v[116:119], v[196:199], 0
s_nop 7
v_cvt_pk_bf16_f32 v48, v208, v212
v_cvt_pk_bf16_f32 v49, v216, v220
v_cvt_pk_bf16_f32 v50, v209, v213
v_cvt_pk_bf16_f32 v51, v217, v221
v_cvt_pk_bf16_f32 v52, v210, v214
v_cvt_pk_bf16_f32 v53, v218, v222
v_cvt_pk_bf16_f32 v54, v211, v215
v_cvt_pk_bf16_f32 v55, v219, v223
ds_write_b128 v36, v[48:51] offset:256
ds_write_b128 v36, v[52:55] offset:272
ds_read_b128 v[152:155], v37 offset:256
ds_read_b128 v[156:159], v37 offset:320
ds_read_b64 v[64:65], v13 offset:0
ds_read_b64 v[66:67], v13 offset:8
ds_read_b64 v[68:69], v13 offset:3232
ds_read_b64 v[70:71], v13 offset:3240
ds_read_b64 v[72:73], v13 offset:64
ds_read_b64 v[74:75], v13 offset:72
ds_read_b64 v[76:77], v13 offset:3296
ds_read_b64 v[78:79], v13 offset:3304
ds_read_b64 v[80:81], v13 offset:128
ds_read_b64 v[82:83], v13 offset:136
ds_read_b64 v[84:85], v13 offset:3360
ds_read_b64 v[86:87], v13 offset:3368
ds_read_b64 v[88:89], v13 offset:192
ds_read_b64 v[90:91], v13 offset:200
ds_read_b64 v[92:93], v13 offset:3424
ds_read_b64 v[94:95], v13 offset:3432
ds_read_b64 v[96:97], v13 offset:256
ds_read_b64 v[98:99], v13 offset:264
ds_read_b64 v[100:101], v13 offset:3488
ds_read_b64 v[102:103], v13 offset:3496
ds_read_b64 v[104:105], v13 offset:320
ds_read_b64 v[106:107], v13 offset:328
ds_read_b64 v[108:109], v13 offset:3552
ds_read_b64 v[110:111], v13 offset:3560
s_mov_b32 s58, 200000
s_branch L_pchk1
L_poll1:
global_load_dwordx4 v[224:227], v38, s[46:47] offset:0 sc1
global_load_dwordx4 v[228:231], v38, s[46:47] offset:1024 sc1
L_pchk1:
s_waitcnt vmcnt(0)
v_xor_b32 v24, s3, v225
v_xor_b32 v25, s3, v227
v_xor_b32 v26, s3, v229
v_xor_b32 v27, s3, v231
v_or3_b32 v24, v24, v25, v26
v_or_b32 v24, v24, v27
v_cmp_ne_u32 vcc, 0, v24
s_sub_u32 s58, s58, 1
s_cbranch_scc1 L_pdone1
s_cbranch_vccnz L_poll1
L_pdone1:
v_and_b32 v225, 0xffff0000, v224
v_lshlrev_b32 v224, 16, v224
v_and_b32 v227, 0xffff0000, v226
v_lshlrev_b32 v226, 16, v226
ds_write_b128 v39, v[224:227] offset:0
v_and_b32 v229, 0xffff0000, v228
v_lshlrev_b32 v228, 16, v228
v_and_b32 v231, 0xffff0000, v230
v_lshlrev_b32 v230, 16, v230
ds_write_b128 v39, v[228:231] offset:1024
L_noep1:
s_waitcnt vmcnt(0)
ds_write_b16 v7, v4 offset:2048
ds_write_b16_d16_hi v7, v4 offset:6720
ds_write_b16 v7, v5 offset:3072
ds_write_b16_d16_hi v7, v5 offset:7744
s_waitcnt lgkmcnt(0)
s_barrier
ds_read_b128 v[40:43], v12 offset:0
ds_read_b128 v[44:47], v12 offset:1024
s_setprio 0
ds_read_b128 v[112:115], v10 offset:1584
ds_read_b128 v[116:119], v10 offset:1600
ds_read_b128 v[120:123], v10 offset:2096
ds_read_b128 v[124:127], v10 offset:2112
v_mfma_f32_16x16x32_bf16 v[224:227], v[188:191], v[88:91], 0
v_mfma_f32_16x16x32_bf16 v[228:231], v[188:191], v[92:95], 0
v_mfma_f32_16x16x32_bf16 v[232:235], v[188:191], v[72:75], 0
v_mfma_f32_16x16x32_bf16 v[236:239], v[188:191], v[76:79], 0
s_waitcnt lgkmcnt(4)
v_mov_b32 v128, 0
v_mov_b32 v129, 0
v_mov_b32 v130, 0
v_mov_b32 v131, 0
ds_write_b128 v11, v[128:131] offset:0
v_mov_b32 v136, 0
v_mov_b32 v137, 0
v_mov_b32 v138, 0
v_mov_b32 v139, 0
ds_write_b128 v11, v[136:139] offset:1024
ds_read_b128 v[40:43], v12 offset:2048
ds_read_b128 v[44:47], v12 offset:3072
s_waitcnt lgkmcnt(6)
v_mfma_f32_16x16x32_bf16 v[208:211], v[112:115], v[192:195], 0
v_mfma_f32_16x16x32_bf16 v[212:215], v[112:115], v[196:199], 0
v_mfma_f32_16x16x32_bf16 v[216:219], v[116:119], v[192:195], 0
v_mfma_f32_16x16x32_bf16 v[220:223], v[116:119], v[196:199], 0
s_waitcnt lgkmcnt(0)
s_barrier
ds_read2st64_b32 v[20:21], v8 offset0:0 offset1:32
ds_read2st64_b32 v[22:23], v8 offset0:8 offset1:40
ds_read2st64_b32 v[24:25], v8 offset0:16 offset1:48
ds_read2st64_b32 v[26:27], v8 offset0:24 offset1:56
ds_read_b32 v28, v9 offset:0
v_mfma_f32_16x16x32_bf16 v[224:227], v[144:147], v[96:99], v[224:227]
v_mfma_f32_16x16x32_bf16 v[228:231], v[144:147], v[100:103], v[228:231]
s_nop 1
v_cvt_pk_bf16_f32 v48, v208, v212
v_cvt_pk_bf16_f32 v49, v216, v220
v_cvt_pk_bf16_f32 v50, v209, v213
v_cvt_pk_bf16_f32 v51, v217, v221
v_cvt_pk_bf16_f32 v52, v210, v214
v_cvt_pk_bf16_f32 v53, v218, v222
v_cvt_pk_bf16_f32 v54, v211, v215
v_cvt_pk_bf16_f32 v55, v219, v223
ds_write_b128 v36, v[48:51] offset:384
ds_write_b128 v36, v[52:55] offset:400
ds_read_b128 v[160:163], v37 offset:384
ds_read_b128 v[164:167], v37 offset:448
v_mfma_f32_16x16x32_bf16 v[208:211], v[120:123], v[192:195], 0
v_mfma_f32_16x16x32_bf16 v[212:215], v[120:123], v[196:199], 0
v_mfma_f32_16x16x32_bf16 v[216:219], v[124:127], v[192:195], 0
v_mfma_f32_16x16x32_bf16 v[220:223], v[124:127], v[196:199], 0
v_lshlrev_b32 v30, 16, v2
v_and_b32 v31, 0xffff0000, v2
s_waitcnt lgkmcnt(4)
v_pk_add_f32 v[20:21], v[20:21], v[22:23]
v_pk_add_f32 v[24:25], v[24:25], v[26:27]
v_pk_fma_f32 v[28:29], v[28:29], v[34:35], v[32:33] op_sel_hi:[0,1,1]
v_pk_add_f32 v[20:21], v[20:21], v[24:25]
v_pk_fma_f32 v[20:21], v[30:31], v[28:29], v[20:21]
v_cvt_pk_bf16_f32 v20, v20, v21
global_store_dword v6, v20, s[42:43]
L_hs10:
v_mfma_f32_16x16x32_bf16 v[232:235], v[144:147], v[80:83], v[232:235]
v_mfma_f32_16x16x32_bf16 v[236:239], v[144:147], v[84:87], v[236:239]
s_nop 1
v_cvt_pk_bf16_f32 v48, v208, v212
v_cvt_pk_bf16_f32 v49, v216, v220
v_cvt_pk_bf16_f32 v50, v209, v213
v_cvt_pk_bf16_f32 v51, v217, v221
v_cvt_pk_bf16_f32 v52, v210, v214
v_cvt_pk_bf16_f32 v53, v218, v222
v_cvt_pk_bf16_f32 v54, v211, v215
v_cvt_pk_bf16_f32 v55, v219, v223
ds_write_b128 v36, v[48:51] offset:512
ds_write_b128 v36, v[52:55] offset:528
ds_read_b128 v[168:171], v37 offset:512
ds_read_b128 v[172:175], v37 offset:576
v_mfma_f32_16x16x32_bf16 v[224:227], v[148:151], v[104:107], v[224:227]
v_mfma_f32_16x16x32_bf16 v[228:231], v[148:151], v[108:111], v[228:231]
v_mfma_f32_16x16x32_bf16 v[232:235], v[148:151], v[88:91], v[232:235]
v_mfma_f32_16x16x32_bf16 v[236:239], v[148:151], v[92:95], v[236:239]
v_mfma_f32_16x16x32_bf16 v[232:235], v[152:155], v[96:99], v[232:235]
v_mfma_f32_16x16x32_bf16 v[236:239], v[152:155], v[100:103], v[236:239]
v_mfma_f32_16x16x32_bf16 v[232:235], v[156:159], v[104:107], v[232:235]
v_mfma_f32_16x16x32_bf16 v[236:239], v[156:159], v[108:111], v[236:239]
ds_read_b128 v[112:115], v10 offset:2608
ds_read_b128 v[116:119], v10 offset:2624
ds_read_b128 v[120:123], v10 offset:3120
ds_read_b128 v[124:127], v10 offset:3136
v_mfma_f32_16x16x32_bf16 v[128:131], v[144:147], v[64:67], 0
v_mfma_f32_16x16x32_bf16 v[132:135], v[144:147], v[68:71], 0
v_mfma_f32_16x16x32_bf16 v[128:131], v[148:151], v[72:75], v[128:131]
v_mfma_f32_16x16x32_bf16 v[132:135], v[148:151], v[76:79], v[132:135]
v_pk_add_f32 v[224:225], v[224:225], v[228:229] neg_lo:[0,1] neg_hi:[0,1]
v_pk_add_f32 v[226:227], v[226:227], v[230:231] neg_lo:[0,1] neg_hi:[0,1]
v_pk_fma_f32 v[224:225], v[40:41], v[224:225], v[228:229]
v_pk_fma_f32 v[226:227], v[42:43], v[226:227], v[230:231]
ds_write_b128 v11, v[224:227] offset:16384
v_pk_add_f32 v[232:233], v[232:233], v[236:237] neg_lo:[0,1] neg_hi:[0,1]
v_pk_add_f32 v[234:235], v[234:235], v[238:239] neg_lo:[0,1] neg_hi:[0,1]
v_pk_fma_f32 v[232:233], v[44:45], v[232:233], v[236:237]
v_pk_fma_f32 v[234:235], v[46:47], v[234:235], v[238:239]
ds_write_b128 v11, v[232:235] offset:17408
ds_read_b128 v[40:43], v12 offset:4096
ds_read_b128 v[44:47], v12 offset:5120
s_waitcnt lgkmcnt(6)
v_mfma_f32_16x16x32_bf16 v[208:211], v[112:115], v[192:195], 0
v_mfma_f32_16x16x32_bf16 v[212:215], v[112:115], v[196:199], 0
v_mfma_f32_16x16x32_bf16 v[216:219], v[116:119], v[192:195], 0
v_mfma_f32_16x16x32_bf16 v[220:223], v[116:119], v[196:199], 0
v_mfma_f32_16x16x32_bf16 v[128:131], v[152:155], v[80:83], v[128:131]
v_mfma_f32_16x16x32_bf16 v[132:135], v[152:155], v[84:87], v[132:135]
s_waitcnt lgkmcnt(0)
s_barrier
ds_read2st64_b32 v[20:21], v8 offset0:64 offset1:96
ds_read2st64_b32 v[22:23], v8 offset0:72 offset1:104
ds_read2st64_b32 v[24:25], v8 offset0:80 offset1:112
ds_read2st64_b32 v[26:27], v8 offset0:88 offset1:120
ds_read_b32 v28, v9 offset:2048
s_nop 1
v_cvt_pk_bf16_f32 v48, v208, v212
v_cvt_pk_bf16_f32 v49, v216, v220
v_cvt_pk_bf16_f32 v50, v209, v213
v_cvt_pk_bf16_f32 v51, v217, v221
v_cvt_pk_bf16_f32 v52, v210, v214
v_cvt_pk_bf16_f32 v53, v218, v222
v_cvt_pk_bf16_f32 v54, v211, v215
v_cvt_pk_bf16_f32 v55, v219, v223
ds_write_b128 v36, v[48:51] offset:640
ds_write_b128 v36, v[52:55] offset:656
ds_read_b128 v[176:179], v37 offset:640
ds_read_b128 v[180:183], v37 offset:704
v_mfma_f32_16x16x32_bf16 v[208:211], v[120:123], v[192:195], 0
v_mfma_f32_16x16x32_bf16 v[212:215], v[120:123], v[196:199], 0
v_mfma_f32_16x16x32_bf16 v[216:219], v[124:127], v[192:195], 0
v_mfma_f32_16x16x32_bf16 v[220:223], v[124:127], v[196:199], 0
v_lshlrev_b32 v30, 16, v3
v_and_b32 v31, 0xffff0000, v3
v_add_u32 v15, 524288, v6
s_waitcnt lgkmcnt(4)
v_pk_add_f32 v[20:21], v[20:21], v[22:23]
v_pk_add_f32 v[24:25], v[24:25], v[26:27]
v_pk_fma_f32 v[28:29], v[28:29], v[34:35], v[32:33] op_sel_hi:[0,1,1]
v_pk_add_f32 v[20:21], v[20:21], v[24:25]
v_pk_fma_f32 v[20:21], v[30:31], v[28:29], v[20:21]
v_cvt_pk_bf16_f32 v20, v20, v21
global_store_dword v15, v20, s[42:43]
L_hs11:
v_mfma_f32_16x16x32_bf16 v[136:139], v[152:155], v[64:67], 0
v_mfma_f32_16x16x32_bf16 v[140:143], v[152:155], v[68:71], 0
s_nop 1
v_cvt_pk_bf16_f32 v48, v208, v212
v_cvt_pk_bf16_f32 v49, v216, v220
v_cvt_pk_bf16_f32 v50, v209, v213
v_cvt_pk_bf16_f32 v51, v217, v221
v_cvt_pk_bf16_f32 v52, v210, v214
v_cvt_pk_bf16_f32 v53, v218, v222
v_cvt_pk_bf16_f32 v54, v211, v215
v_cvt_pk_bf16_f32 v55, v219, v223
ds_write_b128 v36, v[48:51] offset:768
ds_write_b128 v36, v[52:55] offset:784
ds_read_b128 v[184:187], v37 offset:768
ds_read_b128 v[188:191], v37 offset:832
v_mfma_f32_16x16x32_bf16 v[128:131], v[156:159], v[88:91], v[128:131]
v_mfma_f32_16x16x32_bf16 v[132:135], v[156:159], v[92:95], v[132:135]
v_mfma_f32_16x16x32_bf16 v[136:139], v[156:159], v[72:75], v[136:139]
v_mfma_f32_16x16x32_bf16 v[140:143], v[156:159], v[76:79], v[140:143]
v_mfma_f32_16x16x32_bf16 v[128:131], v[160:163], v[96:99], v[128:131]
v_mfma_f32_16x16x32_bf16 v[132:135], v[160:163], v[100:103], v[132:135]
v_mfma_f32_16x16x32_bf16 v[136:139], v[160:163], v[80:83], v[136:139]
v_mfma_f32_16x16x32_bf16 v[140:143], v[160:163], v[84:87], v[140:143]
v_mfma_f32_16x16x32_bf16 v[128:131], v[164:167], v[104:107], v[128:131]
v_mfma_f32_16x16x32_bf16 v[132:135], v[164:167], v[108:111], v[132:135]
v_mfma_f32_16x16x32_bf16 v[136:139], v[164:167], v[88:91], v[136:139]
v_mfma_f32_16x16x32_bf16 v[140:143], v[164:167], v[92:95], v[140:143]
v_mfma_f32_16x16x32_bf16 v[136:139], v[168:171], v[96:99], v[136:139]
v_mfma_f32_16x16x32_bf16 v[140:143], v[168:171], v[100:103], v[140:143]
v_mfma_f32_16x16x32_bf16 v[136:139], v[172:175], v[104:107], v[136:139]
v_mfma_f32_16x16x32_bf16 v[140:143], v[172:175], v[108:111], v[140:143]
v_mfma_f32_16x16x32_bf16 v[224:227], v[160:163], v[64:67], 0
v_mfma_f32_16x16x32_bf16 v[228:231], v[160:163], v[68:71], 0
v_mfma_f32_16x16x32_bf16 v[224:227], v[164:167], v[72:75], v[224:227]
v_mfma_f32_16x16x32_bf16 v[228:231], v[164:167], v[76:79], v[228:231]
v_pk_add_f32 v[128:129], v[128:129], v[132:133] neg_lo:[0,1] neg_hi:[0,1]
v_pk_add_f32 v[130:131], v[130:131], v[134:135] neg_lo:[0,1] neg_hi:[0,1]
v_pk_fma_f32 v[128:129], v[40:41], v[128:129], v[132:133]
v_pk_fma_f32 v[130:131], v[42:43], v[130:131], v[134:135]
ds_write_b128 v11, v[128:131] offset:32768
v_pk_add_f32 v[136:137], v[136:137], v[140:141] neg_lo:[0,1] neg_hi:[0,1]
v_pk_add_f32 v[138:139], v[138:139], v[142:143] neg_lo:[0,1] neg_hi:[0,1]
v_pk_fma_f32 v[136:137], v[44:45], v[136:137], v[140:141]
v_pk_fma_f32 v[138:139], v[46:47], v[138:139], v[142:143]
ds_write_b128 v11, v[136:139] offset:33792
ds_read_b128 v[40:43], v12 offset:6144
ds_read_b128 v[44:47], v12 offset:7168
v_mfma_f32_16x16x32_bf16 v[224:227], v[168:171], v[80:83], v[224:227]
v_mfma_f32_16x16x32_bf16 v[228:231], v[168:171], v[84:87], v[228:231]
v_mfma_f32_16x16x32_bf16 v[232:235], v[168:171], v[64:67], 0
v_mfma_f32_16x16x32_bf16 v[236:239], v[168:171], v[68:71], 0
s_waitcnt lgkmcnt(0)
s_barrier
ds_read2st64_b32 v[20:21], v8 offset0:128 offset1:160
ds_read2st64_b32 v[22:23], v8 offset0:136 offset1:168
ds_read2st64_b32 v[24:25], v8 offset0:144 offset1:176
ds_read2st64_b32 v[26:27], v8 offset0:152 offset1:184
ds_read_b32 v28, v9 offset:4096
v_mfma_f32_16x16x32_bf16 v[224:227], v[172:175], v[88:91], v[224:227]
v_mfma_f32_16x16x32_bf16 v[228:231], v[172:175], v[92:95], v[228:231]
v_mfma_f32_16x16x32_bf16 v[232:235], v[172:175], v[72:75], v[232:235]
v_mfma_f32_16x16x32_bf16 v[236:239], v[172:175], v[76:79], v[236:239]
v_lshlrev_b32 v30, 16, v4
v_and_b32 v31, 0xffff0000, v4
v_add_u32 v15, 1048576, v6
s_waitcnt lgkmcnt(0)
v_pk_add_f32 v[20:21], v[20:21], v[22:23]
v_pk_add_f32 v[24:25], v[24:25], v[26:27]
v_pk_fma_f32 v[28:29], v[28:29], v[34:35], v[32:33] op_sel_hi:[0,1,1]
v_pk_add_f32 v[20:21], v[20:21], v[24:25]
v_pk_fma_f32 v[20:21], v[30:31], v[28:29], v[20:21]
v_cvt_pk_bf16_f32 v20, v20, v21
global_store_dword v15, v20, s[42:43]
L_hs12:
v_mfma_f32_16x16x32_bf16 v[224:227], v[176:179], v[96:99], v[224:227]
v_mfma_f32_16x16x32_bf16 v[228:231], v[176:179], v[100:103], v[228:231]
v_mfma_f32_16x16x32_bf16 v[232:235], v[176:179], v[80:83], v[232:235]
v_mfma_f32_16x16x32_bf16 v[236:239], v[176:179], v[84:87], v[236:239]
v_mfma_f32_16x16x32_bf16 v[224:227], v[180:183], v[104:107], v[224:227]
v_mfma_f32_16x16x32_bf16 v[228:231], v[180:183], v[108:111], v[228:231]
v_mfma_f32_16x16x32_bf16 v[232:235], v[180:183], v[88:91], v[232:235]
v_mfma_f32_16x16x32_bf16 v[236:239], v[180:183], v[92:95], v[236:239]
v_mfma_f32_16x16x32_bf16 v[232:235], v[184:187], v[96:99], v[232:235]
v_mfma_f32_16x16x32_bf16 v[236:239], v[184:187], v[100:103], v[236:239]
v_mfma_f32_16x16x32_bf16 v[232:235], v[188:191], v[104:107], v[232:235]
v_mfma_f32_16x16x32_bf16 v[236:239], v[188:191], v[108:111], v[236:239]
s_nop 7
v_pk_add_f32 v[224:225], v[224:225], v[228:229] neg_lo:[0,1] neg_hi:[0,1]
v_pk_add_f32 v[226:227], v[226:227], v[230:231] neg_lo:[0,1] neg_hi:[0,1]
v_pk_fma_f32 v[224:225], v[40:41], v[224:225], v[228:229]
v_pk_fma_f32 v[226:227], v[42:43], v[226:227], v[230:231]
ds_write_b128 v11, v[224:227] offset:49152
v_pk_add_f32 v[232:233], v[232:233], v[236:237] neg_lo:[0,1] neg_hi:[0,1]
v_pk_add_f32 v[234:235], v[234:235], v[238:239] neg_lo:[0,1] neg_hi:[0,1]
v_pk_fma_f32 v[232:233], v[44:45], v[232:233], v[236:237]
v_pk_fma_f32 v[234:235], v[46:47], v[234:235], v[238:239]
ds_write_b128 v11, v[232:235] offset:50176
s_waitcnt lgkmcnt(0)
s_barrier
ds_read2st64_b32 v[20:21], v8 offset0:192 offset1:224
ds_read2st64_b32 v[22:23], v8 offset0:200 offset1:232
ds_read2st64_b32 v[24:25], v8 offset0:208 offset1:240
ds_read2st64_b32 v[26:27], v8 offset0:216 offset1:248
ds_read_b32 v28, v9 offset:6144
v_lshlrev_b32 v30, 16, v5
v_and_b32 v31, 0xffff0000, v5
v_add_u32 v15, 1572864, v6
s_waitcnt lgkmcnt(0)
v_pk_add_f32 v[20:21], v[20:21], v[22:23]
v_pk_add_f32 v[24:25], v[24:25], v[26:27]
v_pk_fma_f32 v[28:29], v[28:29], v[34:35], v[32:33] op_sel_hi:[0,1,1]
v_pk_add_f32 v[20:21], v[20:21], v[24:25]
v_pk_fma_f32 v[20:21], v[30:31], v[28:29], v[20:21]
v_cvt_pk_bf16_f32 v20, v20, v21
global_store_dword v15, v20, s[42:43]
L_hs13:
s_branch L_fin
L_role2:
ds_read2_b32 v[64:65], v13 offset0:176 offset1:177
ds_read2_b32 v[66:67], v13 offset0:178 offset1:179
ds_read2_b32 v[68:69], v14 offset0:176 offset1:177
ds_read2_b32 v[70:71], v14 offset0:178 offset1:179
ds_read2_b32 v[72:73], v13 offset0:160 offset1:161
ds_read2_b32 v[74:75], v13 offset0:162 offset1:163
ds_read2_b32 v[76:77], v14 offset0:160 offset1:161
ds_read2_b32 v[78:79], v14 offset0:162 offset1:163
ds_read2_b32 v[80:81], v13 offset0:144 offset1:145
ds_read2_b32 v[82:83], v13 offset0:146 offset1:147
ds_read2_b32 v[84:85], v14 offset0:144 offset1:145
ds_read2_b32 v[86:87], v14 offset0:146 offset1:147
ds_read2_b32 v[88:89], v13 offset0:128 offset1:129
ds_read2_b32 v[90:91], v13 offset0:130 offset1:131
ds_read2_b32 v[92:93], v14 offset0:128 offset1:129
ds_read2_b32 v[94:95], v14 offset0:130 offset1:131
ds_read2_b32 v[96:97], v13 offset0:48 offset1:49
ds_read2_b32 v[98:99], v13 offset0:50 offset1:51
ds_read2_b32 v[100:101], v14 offset0:48 offset1:49
ds_read2_b32 v[102:103], v14 offset0:50 offset1:51
ds_read2_b32 v[104:105], v13 offset0:32 offset1:33
ds_read2_b32 v[106:107], v13 offset0:34 offset1:35
ds_read2_b32 v[108:109], v14 offset0:32 offset1:33
ds_read2_b32 v[110:111], v14 offset0:34 offset1:35
ds_read2_b32 v[112:113], v13 offset0:16 offset1:17
ds_read2_b32 v[114:115], v13 offset0:18 offset1:19
ds_read2_b32 v[116:117], v14 offset0:16 offset1:17
ds_read2_b32 v[118:119], v14 offset0:18 offset1:19
s_waitcnt lgkmcnt(15)
v_mfma_f32_16x16x32_bf16 v[128:131], v[64:67], v[176:179], 0
v_mfma_f32_16x16x32_bf16 v[132:135], v[68:71], v[176:179], 0
v_mfma_f32_16x16x32_bf16 v[128:131], v[72:75], v[180:183], v[128:131]
v_mfma_f32_16x16x32_bf16 v[132:135], v[76:79], v[180:183], v[132:135]
v_mfma_f32_16x16x32_bf16 v[128:131], v[80:83], v[184:187], v[128:131]
v_mfma_f32_16x16x32_bf16 v[132:135], v[84:87], v[184:187], v[132:135]
s_waitcnt lgkmcnt(12)
v_mfma_f32_16x16x32_bf16 v[128:131], v[88:91], v[188:191], v[128:131]
v_mfma_f32_16x16x32_bf16 v[132:135], v[92:95], v[188:191], v[132:135]
ds_read_b128 v[208:211], v10 offset:1312
ds_read_b128 v[212:215], v10 offset:1248
ds_read_b128 v[216:219], v10 offset:1184
ds_read_b128 v[220:223], v10 offset:1120
v_mfma_f32_16x16x32_bf16 v[136:139], v[64:67], v[144:147], 0
v_mfma_f32_16x16x32_bf16 v[140:143], v[68:71], v[144:147], 0
s_waitcnt lgkmcnt(12)
v_mfma_f32_16x16x32_bf16 v[136:139], v[96:99], v[176:179], v[136:139]
v_mfma_f32_16x16x32_bf16 v[140:143], v[100:103], v[176:179], v[140:143]
v_mfma_f32_16x16x32_bf16 v[136:139], v[72:75], v[148:151], v[136:139]
v_mfma_f32_16x16x32_bf16 v[140:143], v[76:79], v[148:151], v[140:143]
s_waitcnt lgkmcnt(8)
v_mfma_f32_16x16x32_bf16 v[136:139], v[104:107], v[180:183], v[136:139]
v_mfma_f32_16x16x32_bf16 v[140:143], v[108:111], v[180:183], v[140:143]
v_mfma_f32_16x16x32_bf16 v[136:139], v[80:83], v[152:155], v[136:139]
v_mfma_f32_16x16x32_bf16 v[140:143], v[84:87], v[152:155], v[140:143]
s_waitcnt lgkmcnt(4)
v_mfma_f32_16x16x32_bf16 v[136:139], v[112:115], v[184:187], v[136:139]
v_mfma_f32_16x16x32_bf16 v[140:143], v[116:119], v[184:187], v[140:143]
v_mfma_f32_16x16x32_bf16 v[136:139], v[88:91], v[156:159], v[136:139]
v_mfma_f32_16x16x32_bf16 v[140:143], v[92:95], v[156:159], v[140:143]
s_waitcnt vmcnt(0)
ds_write_b16 v7, v4 offset:2048
ds_write_b16_d16_hi v7, v4 offset:6720
ds_write_b16 v7, v5 offset:3072
ds_write_b16_d16_hi v7, v5 offset:7744
s_waitcnt lgkmcnt(0)
s_barrier
ds_read_b128 v[40:43], v12 offset:0
ds_read_b128 v[44:47], v12 offset:1024
v_mfma_f32_16x16x32_bf16 v[224:227], v[96:99], v[144:147], 0
v_mfma_f32_16x16x32_bf16 v[228:231], v[100:103], v[144:147], 0
v_mfma_f32_16x16x32_bf16 v[224:227], v[104:107], v[148:151], v[224:227]
v_mfma_f32_16x16x32_bf16 v[228:231], v[108:111], v[148:151], v[228:231]
s_waitcnt lgkmcnt(0)
v_pk_add_f32 v[128:129], v[128:129], v[132:133] neg_lo:[0,1] neg_hi:[0,1]
v_pk_add_f32 v[130:131], v[130:131], v[134:135] neg_lo:[0,1] neg_hi:[0,1]
v_pk_fma_f32 v[128:129], v[40:41], v[128:129], v[132:133]
v_pk_fma_f32 v[130:131], v[42:43], v[130:131], v[134:135]
ds_write_b128 v11, v[128:131] offset:0
v_pk_add_f32 v[136:137], v[136:137], v[140:141] neg_lo:[0,1] neg_hi:[0,1]
v_pk_add_f32 v[138:139], v[138:139], v[142:143] neg_lo:[0,1] neg_hi:[0,1]
v_pk_fma_f32 v[136:137], v[44:45], v[136:137], v[140:141]
v_pk_fma_f32 v[138:139], v[46:47], v[138:139], v[142:143]
ds_write_b128 v11, v[136:139] offset:1024
ds_read_b128 v[40:43], v12 offset:2048
ds_read_b128 v[44:47], v12 offset:3072
v_mfma_f32_16x16x32_bf16 v[224:227], v[112:115], v[152:155], v[224:227]
v_mfma_f32_16x16x32_bf16 v[228:231], v[116:119], v[152:155], v[228:231]
ds_read_b128 v[160:163], v10 offset:1824
ds_read_b128 v[164:167], v10 offset:1760
ds_read_b128 v[168:171], v10 offset:1696
ds_read_b128 v[172:175], v10 offset:1632
v_mfma_f32_16x16x32_bf16 v[224:227], v[64:67], v[208:211], v[224:227]
v_mfma_f32_16x16x32_bf16 v[228:231], v[68:71], v[208:211], v[228:231]
s_waitcnt lgkmcnt(0)
s_barrier
ds_read2st64_b32 v[20:21], v8 offset0:0 offset1:32
ds_read2st64_b32 v[22:23], v8 offset0:8 offset1:40
ds_read2st64_b32 v[24:25], v8 offset0:16 offset1:48
ds_read2st64_b32 v[26:27], v8 offset0:24 offset1:56
ds_read_b32 v28, v9 offset:0
v_mfma_f32_16x16x32_bf16 v[232:235], v[96:99], v[208:211], 0
v_mfma_f32_16x16x32_bf16 v[236:239], v[100:103], v[208:211], 0
v_mfma_f32_16x16x32_bf16 v[224:227], v[72:75], v[212:215], v[224:227]
v_mfma_f32_16x16x32_bf16 v[228:231], v[76:79], v[212:215], v[228:231]
v_lshlrev_b32 v30, 16, v2
v_and_b32 v31, 0xffff0000, v2
s_waitcnt lgkmcnt(0)
v_pk_add_f32 v[20:21], v[20:21], v[22:23]
v_pk_add_f32 v[24:25], v[24:25], v[26:27]
v_pk_fma_f32 v[28:29], v[28:29], v[34:35], v[32:33] op_sel_hi:[0,1,1]
v_pk_add_f32 v[20:21], v[20:21], v[24:25]
v_pk_fma_f32 v[20:21], v[30:31], v[28:29], v[20:21]
v_cvt_pk_bf16_f32 v20, v20, v21
global_store_dword v6, v20, s[42:43]
L_hs20:
v_mfma_f32_16x16x32_bf16 v[232:235], v[104:107], v[212:215], v[232:235]
v_mfma_f32_16x16x32_bf16 v[236:239], v[108:111], v[212:215], v[236:239]
v_mfma_f32_16x16x32_bf16 v[224:227], v[80:83], v[216:219], v[224:227]
v_mfma_f32_16x16x32_bf16 v[228:231], v[84:87], v[216:219], v[228:231]
v_mfma_f32_16x16x32_bf16 v[232:235], v[112:115], v[216:219], v[232:235]
v_mfma_f32_16x16x32_bf16 v[236:239], v[116:119], v[216:219], v[236:239]
v_mfma_f32_16x16x32_bf16 v[224:227], v[88:91], v[220:223], v[224:227]
v_mfma_f32_16x16x32_bf16 v[228:231], v[92:95], v[220:223], v[228:231]
ds_read_b128 v[176:179], v10 offset:2336
ds_read_b128 v[180:183], v10 offset:2272
ds_read_b128 v[184:187], v10 offset:2208
ds_read_b128 v[188:191], v10 offset:2144
v_mfma_f32_16x16x32_bf16 v[232:235], v[64:67], v[160:163], v[232:235]
v_mfma_f32_16x16x32_bf16 v[236:239], v[68:71], v[160:163], v[236:239]
v_mfma_f32_16x16x32_bf16 v[232:235], v[72:75], v[164:167], v[232:235]
v_mfma_f32_16x16x32_bf16 v[236:239], v[76:79], v[164:167], v[236:239]
v_mfma_f32_16x16x32_bf16 v[232:235], v[80:83], v[168:171], v[232:235]
v_mfma_f32_16x16x32_bf16 v[236:239], v[84:87], v[168:171], v[236:239]
v_mfma_f32_16x16x32_bf16 v[232:235], v[88:91], v[172:175], v[232:235]
v_mfma_f32_16x16x32_bf16 v[236:239], v[92:95], v[172:175], v[236:239]
v_mfma_f32_16x16x32_bf16 v[128:131], v[96:99], v[160:163], 0
v_mfma_f32_16x16x32_bf16 v[132:135], v[100:103], v[160:163], 0
v_mfma_f32_16x16x32_bf16 v[128:131], v[104:107], v[164:167], v[128:131]
v_mfma_f32_16x16x32_bf16 v[132:135], v[108:111], v[164:167], v[132:135]
v_pk_add_f32 v[224:225], v[224:225], v[228:229] neg_lo:[0,1] neg_hi:[0,1]
v_pk_add_f32 v[226:227], v[226:227], v[230:231] neg_lo:[0,1] neg_hi:[0,1]
v_pk_fma_f32 v[224:225], v[40:41], v[224:225], v[228:229]
v_pk_fma_f32 v[226:227], v[42:43], v[226:227], v[230:231]
ds_write_b128 v11, v[224:227] offset:16384
v_pk_add_f32 v[232:233], v[232:233], v[236:237] neg_lo:[0,1] neg_hi:[0,1]
v_pk_add_f32 v[234:235], v[234:235], v[238:239] neg_lo:[0,1] neg_hi:[0,1]
v_pk_fma_f32 v[232:233], v[44:45], v[232:233], v[236:237]
v_pk_fma_f32 v[234:235], v[46:47], v[234:235], v[238:239]
ds_write_b128 v11, v[232:235] offset:17408
ds_read_b128 v[40:43], v12 offset:4096
ds_read_b128 v[44:47], v12 offset:5120
v_mfma_f32_16x16x32_bf16 v[128:131], v[112:115], v[168:171], v[128:131]
v_mfma_f32_16x16x32_bf16 v[132:135], v[116:119], v[168:171], v[132:135]
ds_read_b128 v[144:147], v10 offset:2848
ds_read_b128 v[148:151], v10 offset:2784
ds_read_b128 v[152:155], v10 offset:2720
ds_read_b128 v[156:159], v10 offset:2656
s_waitcnt lgkmcnt(11)
v_mfma_f32_16x16x32_bf16 v[128:131], v[64:67], v[176:179], v[128:131]
v_mfma_f32_16x16x32_bf16 v[132:135], v[68:71], v[176:179], v[132:135]
s_waitcnt lgkmcnt(0)
s_barrier
ds_read2st64_b32 v[20:21], v8 offset0:64 offset1:96
ds_read2st64_b32 v[22:23], v8 offset0:72 offset1:104
ds_read2st64_b32 v[24:25], v8 offset0:80 offset1:112
ds_read2st64_b32 v[26:27], v8 offset0:88 offset1:120
ds_read_b32 v28, v9 offset:2048
v_mfma_f32_16x16x32_bf16 v[136:139], v[96:99], v[176:179], 0
v_mfma_f32_16x16x32_bf16 v[140:143], v[100:103], v[176:179], 0
v_mfma_f32_16x16x32_bf16 v[128:131], v[72:75], v[180:183], v[128:131]
v_mfma_f32_16x16x32_bf16 v[132:135], v[76:79], v[180:183], v[132:135]
v_lshlrev_b32 v30, 16, v3
v_and_b32 v31, 0xffff0000, v3
v_add_u32 v15, 524288, v6
s_waitcnt lgkmcnt(0)
v_pk_add_f32 v[20:21], v[20:21], v[22:23]
v_pk_add_f32 v[24:25], v[24:25], v[26:27]
v_pk_fma_f32 v[28:29], v[28:29], v[34:35], v[32:33] op_sel_hi:[0,1,1]
v_pk_add_f32 v[20:21], v[20:21], v[24:25]
v_pk_fma_f32 v[20:21], v[30:31], v[28:29], v[20:21]
v_cvt_pk_bf16_f32 v20, v20, v21
global_store_dword v15, v20, s[42:43]
L_hs21:
v_mfma_f32_16x16x32_bf16 v[136:139], v[104:107], v[180:183], v[136:139]
v_mfma_f32_16x16x32_bf16 v[140:143], v[108:111], v[180:183], v[140:143]
v_mfma_f32_16x16x32_bf16 v[128:131], v[80:83], v[184:187], v[128:131]
v_mfma_f32_16x16x32_bf16 v[132:135], v[84:87], v[184:187], v[132:135]
v_mfma_f32_16x16x32_bf16 v[136:139], v[112:115], v[184:187], v[136:139]
v_mfma_f32_16x16x32_bf16 v[140:143], v[116:119], v[184:187], v[140:143]
v_mfma_f32_16x16x32_bf16 v[128:131], v[88:91], v[188:191], v[128:131]
v_mfma_f32_16x16x32_bf16 v[132:135], v[92:95], v[188:191], v[132:135]
ds_read_b128 v[208:211], v10 offset:3360
ds_read_b128 v[212:215], v10 offset:3296
ds_read_b128 v[216:219], v10 offset:3232
ds_read_b128 v[220:223], v10 offset:3168
v_mfma_f32_16x16x32_bf16 v[136:139], v[64:67], v[144:147], v[136:139]
v_mfma_f32_16x16x32_bf16 v[140:143], v[68:71], v[144:147], v[140:143]
v_mfma_f32_16x16x32_bf16 v[136:139], v[72:75], v[148:151], v[136:139]
v_mfma_f32_16x16x32_bf16 v[140:143], v[76:79], v[148:151], v[140:143]
v_mfma_f32_16x16x32_bf16 v[136:139], v[80:83], v[152:155], v[136:139]
v_mfma_f32_16x16x32_bf16 v[140:143], v[84:87], v[152:155], v[140:143]
v_mfma_f32_16x16x32_bf16 v[136:139], v[88:91], v[156:159], v[136:139]
v_mfma_f32_16x16x32_bf16 v[140:143], v[92:95], v[156:159], v[140:143]
v_mfma_f32_16x16x32_bf16 v[224:227], v[96:99], v[144:147], 0
v_mfma_f32_16x16x32_bf16 v[228:231], v[100:103], v[144:147], 0
v_mfma_f32_16x16x32_bf16 v[224:227], v[104:107], v[148:151], v[224:227]
v_mfma_f32_16x16x32_bf16 v[228:231], v[108:111], v[148:151], v[228:231]
v_pk_add_f32 v[128:129], v[128:129], v[132:133] neg_lo:[0,1] neg_hi:[0,1]
v_pk_add_f32 v[130:131], v[130:131], v[134:135] neg_lo:[0,1] neg_hi:[0,1]
v_pk_fma_f32 v[128:129], v[40:41], v[128:129], v[132:133]
v_pk_fma_f32 v[130:131], v[42:43], v[130:131], v[134:135]
ds_write_b128 v11, v[128:131] offset:32768
v_pk_add_f32 v[136:137], v[136:137], v[140:141] neg_lo:[0,1] neg_hi:[0,1]
v_pk_add_f32 v[138:139], v[138:139], v[142:143] neg_lo:[0,1] neg_hi:[0,1]
v_pk_fma_f32 v[136:137], v[44:45], v[136:137], v[140:141]
v_pk_fma_f32 v[138:139], v[46:47], v[138:139], v[142:143]
ds_write_b128 v11, v[136:139] offset:33792
ds_read_b128 v[40:43], v12 offset:6144
ds_read_b128 v[44:47], v12 offset:7168
v_mfma_f32_16x16x32_bf16 v[224:227], v[112:115], v[152:155], v[224:227]
v_mfma_f32_16x16x32_bf16 v[228:231], v[116:119], v[152:155], v[228:231]
ds_read_b128 v[160:163], v10 offset:3872
ds_read_b128 v[164:167], v10 offset:3808
ds_read_b128 v[168:171], v10 offset:3744
ds_read_b128 v[172:175], v10 offset:3680
s_waitcnt lgkmcnt(11)
v_mfma_f32_16x16x32_bf16 v[224:227], v[64:67], v[208:211], v[224:227]
v_mfma_f32_16x16x32_bf16 v[228:231], v[68:71], v[208:211], v[228:231]
s_waitcnt lgkmcnt(0)
s_barrier
ds_read2st64_b32 v[20:21], v8 offset0:128 offset1:160
ds_read2st64_b32 v[22:23], v8 offset0:136 offset1:168
ds_read2st64_b32 v[24:25], v8 offset0:144 offset1:176
ds_read2st64_b32 v[26:27], v8 offset0:152 offset1:184
ds_read_b32 v28, v9 offset:4096
v_mfma_f32_16x16x32_bf16 v[232:235], v[96:99], v[208:211], 0
v_mfma_f32_16x16x32_bf16 v[236:239], v[100:103], v[208:211], 0
v_mfma_f32_16x16x32_bf16 v[224:227], v[72:75], v[212:215], v[224:227]
v_mfma_f32_16x16x32_bf16 v[228:231], v[76:79], v[212:215], v[228:231]
v_lshlrev_b32 v30, 16, v4
v_and_b32 v31, 0xffff0000, v4
v_add_u32 v15, 1048576, v6
s_waitcnt lgkmcnt(0)
v_pk_add_f32 v[20:21], v[20:21], v[22:23]
v_pk_add_f32 v[24:25], v[24:25], v[26:27]
v_pk_fma_f32 v[28:29], v[28:29], v[34:35], v[32:33] op_sel_hi:[0,1,1]
v_pk_add_f32 v[20:21], v[20:21], v[24:25]
v_pk_fma_f32 v[20:21], v[30:31], v[28:29], v[20:21]
v_cvt_pk_bf16_f32 v20, v20, v21
global_store_dword v15, v20, s[42:43]
L_hs22:
v_mfma_f32_16x16x32_bf16 v[232:235], v[104:107], v[212:215], v[232:235]
v_mfma_f32_16x16x32_bf16 v[236:239], v[108:111], v[212:215], v[236:239]
v_mfma_f32_16x16x32_bf16 v[224:227], v[80:83], v[216:219], v[224:227]
v_mfma_f32_16x16x32_bf16 v[228:231], v[84:87], v[216:219], v[228:231]
v_mfma_f32_16x16x32_bf16 v[232:235], v[112:115], v[216:219], v[232:235]
v_mfma_f32_16x16x32_bf16 v[236:239], v[116:119], v[216:219], v[236:239]
v_mfma_f32_16x16x32_bf16 v[224:227], v[88:91], v[220:223], v[224:227]
v_mfma_f32_16x16x32_bf16 v[228:231], v[92:95], v[220:223], v[228:231]
v_mfma_f32_16x16x32_bf16 v[232:235], v[64:67], v[160:163], v[232:235]
v_mfma_f32_16x16x32_bf16 v[236:239], v[68:71], v[160:163], v[236:239]
v_mfma_f32_16x16x32_bf16 v[232:235], v[72:75], v[164:167], v[232:235]
v_mfma_f32_16x16x32_bf16 v[236:239], v[76:79], v[164:167], v[236:239]
v_mfma_f32_16x16x32_bf16 v[232:235], v[80:83], v[168:171], v[232:235]
v_mfma_f32_16x16x32_bf16 v[236:239], v[84:87], v[168:171], v[236:239]
v_mfma_f32_16x16x32_bf16 v[232:235], v[88:91], v[172:175], v[232:235]
v_mfma_f32_16x16x32_bf16 v[236:239], v[92:95], v[172:175], v[236:239]
s_nop 7
v_pk_add_f32 v[224:225], v[224:225], v[228:229] neg_lo:[0,1] neg_hi:[0,1]
v_pk_add_f32 v[226:227], v[226:227], v[230:231] neg_lo:[0,1] neg_hi:[0,1]
v_pk_fma_f32 v[224:225], v[40:41], v[224:225], v[228:229]
v_pk_fma_f32 v[226:227], v[42:43], v[226:227], v[230:231]
ds_write_b128 v11, v[224:227] offset:49152
v_pk_add_f32 v[232:233], v[232:233], v[236:237] neg_lo:[0,1] neg_hi:[0,1]
v_pk_add_f32 v[234:235], v[234:235], v[238:239] neg_lo:[0,1] neg_hi:[0,1]
v_pk_fma_f32 v[232:233], v[44:45], v[232:233], v[236:237]
v_pk_fma_f32 v[234:235], v[46:47], v[234:235], v[238:239]
ds_write_b128 v11, v[232:235] offset:50176
s_waitcnt lgkmcnt(0)
s_barrier
ds_read2st64_b32 v[20:21], v8 offset0:192 offset1:224
ds_read2st64_b32 v[22:23], v8 offset0:200 offset1:232
ds_read2st64_b32 v[24:25], v8 offset0:208 offset1:240
ds_read2st64_b32 v[26:27], v8 offset0:216 offset1:248
ds_read_b32 v28, v9 offset:6144
v_lshlrev_b32 v30, 16, v5
v_and_b32 v31, 0xffff0000, v5
v_add_u32 v15, 1572864, v6
s_waitcnt lgkmcnt(0)
v_pk_add_f32 v[20:21], v[20:21], v[22:23]
v_pk_add_f32 v[24:25], v[24:25], v[26:27]
v_pk_fma_f32 v[28:29], v[28:29], v[34:35], v[32:33] op_sel_hi:[0,1,1]
v_pk_add_f32 v[20:21], v[20:21], v[24:25]
v_pk_fma_f32 v[20:21], v[30:31], v[28:29], v[20:21]
v_cvt_pk_bf16_f32 v20, v20, v21
global_store_dword v15, v20, s[42:43]
L_hs23:
s_branch L_fin
L_role3:
s_setprio 2
ds_read2_b32 v[104:105], v13 offset0:0 offset1:1
ds_read2_b32 v[106:107], v13 offset0:2 offset1:3
ds_read2_b32 v[108:109], v14 offset0:0 offset1:1
ds_read2_b32 v[110:111], v14 offset0:2 offset1:3
ds_read2_b32 v[120:121], v13 offset0:16 offset1:17
ds_read2_b32 v[122:123], v13 offset0:18 offset1:19
ds_read2_b32 v[124:125], v14 offset0:16 offset1:17
ds_read2_b32 v[126:127], v14 offset0:18 offset1:19
ds_read_u16 v22, v206 offset:3164
ds_read_u16 v23, v206 offset:6396
s_mov_b32 s57, 511
s_mov_b32 s73, 16256
v_add_u32 v24, 13, v19
v_med3_i32 v24, v24, 0, 17
v_lshlrev_b32 v24, v24, s57
v_bfe_u32 v192, v24, 9, 2
v_bfe_u32 v193, v24, 11, 2
v_bfe_u32 v194, v24, 13, 2
v_bfe_u32 v195, v24, 15, 2
v_mul_u32_u24 v192, 0x8001, v192
v_mul_u32_u24 v193, 0x8001, v193
v_mul_u32_u24 v194, 0x8001, v194
v_mul_u32_u24 v195, 0x8001, v195
v_and_b32 v192, 0x10001, v192
v_and_b32 v193, 0x10001, v193
v_and_b32 v194, 0x10001, v194
v_and_b32 v195, 0x10001, v195
v_mul_u32_u24 v192, s73, v192
v_mul_u32_u24 v193, s73, v193
v_mul_u32_u24 v194, s73, v194
v_mul_u32_u24 v195, s73, v195
s_mov_b32 s57, 127
s_mov_b32 s73, 16256
v_add_u32 v24, 14, v19
v_med3_i32 v24, v24, 0, 17
v_lshlrev_b32 v24, v24, s57
v_bfe_u32 v196, v24, 9, 2
v_bfe_u32 v197, v24, 11, 2
v_bfe_u32 v198, v24, 13, 2
v_bfe_u32 v199, v24, 15, 2
v_mul_u32_u24 v196, 0x8001, v196
v_mul_u32_u24 v197, 0x8001, v197
v_mul_u32_u24 v198, 0x8001, v198
v_mul_u32_u24 v199, 0x8001, v199
v_and_b32 v196, 0x10001, v196
v_and_b32 v197, 0x10001, v197
v_and_b32 v198, 0x10001, v198
v_and_b32 v199, 0x10001, v199
v_mul_u32_u24 v196, s73, v196
v_mul_u32_u24 v197, s73, v197
v_mul_u32_u24 v198, s73, v198
v_mul_u32_u24 v199, s73, v199
s_mov_b32 s57, 1
s_mov_b32 s73, 65535
v_add_u32 v24, 14, v19
v_med3_i32 v24, v24, 0, 17
v_lshlrev_b32 v24, v24, s57
v_bfe_u32 v200, v24, 9, 2
v_bfe_u32 v201, v24, 11, 2
v_bfe_u32 v202, v24, 13, 2
v_bfe_u32 v203, v24, 15, 2
v_mul_u32_u24 v200, 0x8001, v200
v_mul_u32_u24 v201, 0x8001, v201
v_mul_u32_u24 v202, 0x8001, v202
v_mul_u32_u24 v203, 0x8001, v203
v_and_b32 v200, 0x10001, v200
v_and_b32 v201, 0x10001, v201
v_and_b32 v202, 0x10001, v202
v_and_b32 v203, 0x10001, v203
v_mul_u32_u24 v200, s73, v200
v_mul_u32_u24 v201, s73, v201
v_mul_u32_u24 v202, s73, v202
v_mul_u32_u24 v203, s73, v203
v_mfma_f32_16x16x32_bf16 v[208:211], v[48:51], v[192:195], 0
v_mfma_f32_16x16x32_bf16 v[212:215], v[52:55], v[196:199], 0
s_waitcnt lgkmcnt(6)
v_mfma_f32_16x16x32_bf16 v[136:139], v[104:107], v[168:171], 0
v_mfma_f32_16x16x32_bf16 v[140:143], v[108:111], v[168:171], 0
s_nop 1
v_cvt_pk_bf16_f32 v188, v208, v212
v_cvt_pk_bf16_f32 v189, v209, v213
v_cvt_pk_bf16_f32 v190, v210, v214
v_cvt_pk_bf16_f32 v191, v211, v215
ds_write_b128 v36, v[188:191] offset:0
ds_read_b128 v[144:147], v36 offset:0
v_mfma_f32_16x16x32_bf16 v[216:219], v[56:59], v[192:195], 0
v_mfma_f32_16x16x32_bf16 v[220:223], v[60:63], v[196:199], 0
ds_read_b128 v[48:51], v10 offset:1072
ds_read_b128 v[52:55], v10 offset:1088
s_waitcnt lgkmcnt(6)
v_mfma_f32_16x16x32_bf16 v[136:139], v[120:123], v[176:179], v[136:139]
v_mfma_f32_16x16x32_bf16 v[140:143], v[124:127], v[176:179], v[140:143]
s_nop 1
v_cvt_pk_bf16_f32 v188, v216, v220
v_cvt_pk_bf16_f32 v189, v217, v221
v_cvt_pk_bf16_f32 v190, v218, v222
v_cvt_pk_bf16_f32 v191, v219, v223
ds_write_b128 v36, v[188:191] offset:64
ds_read_b128 v[148:151], v36 offset:64
s_waitcnt lgkmcnt(2)
v_mfma_f32_16x16x32_bf16 v[208:211], v[48:51], v[192:195], 0
v_mfma_f32_16x16x32_bf16 v[212:215], v[52:55], v[196:199], 0
s_nop 7
v_cvt_pk_bf16_f32 v188, v208, v212
v_cvt_pk_bf16_f32 v189, v209, v213
v_cvt_pk_bf16_f32 v190, v210, v214
v_cvt_pk_bf16_f32 v191, v211, v215
ds_write_b128 v36, v[188:191] offset:128
ds_read_b128 v[152:155], v36 offset:128
v_lshl_or_b32 v22, v22, 16, v22
v_and_b32 v112, v22, v200
v_and_b32 v113, v22, v201
v_and_b32 v114, v22, v202
v_and_b32 v115, v22, v203
v_lshl_or_b32 v23, v23, 16, v23
v_and_b32 v116, v23, v200
v_and_b32 v117, v23, v201
v_and_b32 v118, v23, v202
v_and_b32 v119, v23, v203
ds_read_b128 v[164:167], v10 offset:544
ds_read_b128 v[172:175], v10 offset:608
ds_read_b128 v[168:171], v10 offset:1056
ds_read_b128 v[176:179], v10 offset:1120
ds_read_b128 v[184:187], v10 offset:64
ds_read2_b32 v[96:97], v204 offset0:64 offset1:65
ds_read2_b32 v[98:99], v204 offset0:66 offset1:67
ds_read2_b32 v[100:101], v205 offset0:64 offset1:65
ds_read2_b32 v[102:103], v205 offset0:66 offset1:67
s_mov_b32 s58, 200000
s_branch L_pchk3
L_poll3:
global_load_dwordx4 v[224:227], v38, s[46:47] offset:0 sc1
global_load_dwordx4 v[228:231], v38, s[46:47] offset:1024 sc1
L_pchk3:
s_waitcnt vmcnt(0)
v_xor_b32 v24, s3, v225
v_xor_b32 v25, s3, v227
v_xor_b32 v26, s3, v229
v_xor_b32 v27, s3, v231
v_or3_b32 v24, v24, v25, v26
v_or_b32 v24, v24, v27
v_cmp_ne_u32 vcc, 0, v24
s_sub_u32 s58, s58, 1
s_cbranch_scc1 L_pdone3
s_cbranch_vccnz L_poll3
L_pdone3:
v_and_b32 v225, 0xffff0000, v224
v_lshlrev_b32 v224, 16, v224
v_and_b32 v227, 0xffff0000, v226
v_lshlrev_b32 v226, 16, v226
ds_write_b128 v39, v[224:227] offset:0
v_and_b32 v229, 0xffff0000, v228
v_lshlrev_b32 v228, 16, v228
v_and_b32 v231, 0xffff0000, v230
v_lshlrev_b32 v230, 16, v230
ds_write_b128 v39, v[228:231] offset:1024
L_noep3:
s_waitcnt vmcnt(0)
ds_write_b16 v7, v4 offset:2048
ds_write_b16_d16_hi v7, v4 offset:6720
ds_write_b16 v7, v5 offset:3072
ds_write_b16_d16_hi v7, v5 offset:7744
s_waitcnt lgkmcnt(0)
s_barrier
ds_read_b128 v[40:43], v12 offset:0
ds_read_b128 v[44:47], v12 offset:1024
s_setprio 0
ds_read_b128 v[48:51], v10 offset:1584
ds_read_b128 v[52:55], v10 offset:1600
ds_read_b128 v[56:59], v10 offset:2096
ds_read_b128 v[60:63], v10 offset:2112
v_mfma_f32_16x16x32_bf16 v[232:235], v[144:147], v[96:99], 0
v_mfma_f32_16x16x32_bf16 v[236:239], v[144:147], v[100:103], 0
v_mfma_f32_16x16x32_bf16 v[224:227], v[104:107], v[164:167], 0
v_mfma_f32_16x16x32_bf16 v[228:231], v[108:111], v[164:167], 0
s_waitcnt lgkmcnt(4)
v_mov_b32 v128, 0
v_mov_b32 v129, 0
v_mov_b32 v130, 0
v_mov_b32 v131, 0
ds_write_b128 v11, v[128:131] offset:0
v_pk_add_f32 v[136:137], v[136:137], v[140:141] neg_lo:[0,1] neg_hi:[0,1]
v_pk_add_f32 v[138:139], v[138:139], v[142:143] neg_lo:[0,1] neg_hi:[0,1]
v_pk_fma_f32 v[136:137], v[44:45], v[136:137], v[140:141]
v_pk_fma_f32 v[138:139], v[46:47], v[138:139], v[142:143]
ds_write_b128 v11, v[136:139] offset:1024
ds_read_b128 v[40:43], v12 offset:2048
ds_read_b128 v[44:47], v12 offset:3072
s_waitcnt lgkmcnt(6)
v_mfma_f32_16x16x32_bf16 v[208:211], v[48:51], v[192:195], 0
v_mfma_f32_16x16x32_bf16 v[212:215], v[52:55], v[196:199], 0
s_waitcnt lgkmcnt(0)
s_barrier
ds_read2st64_b32 v[20:21], v8 offset0:0 offset1:32
ds_read2st64_b32 v[22:23], v8 offset0:8 offset1:40
ds_read2st64_b32 v[24:25], v8 offset0:16 offset1:48
ds_read2st64_b32 v[26:27], v8 offset0:24 offset1:56
ds_read_b32 v28, v9 offset:0
v_mfma_f32_16x16x32_bf16 v[224:227], v[120:123], v[172:175], v[224:227]
v_mfma_f32_16x16x32_bf16 v[228:231], v[124:127], v[172:175], v[228:231]
s_nop 1
v_cvt_pk_bf16_f32 v188, v208, v212
v_cvt_pk_bf16_f32 v189, v209, v213
v_cvt_pk_bf16_f32 v190, v210, v214
v_cvt_pk_bf16_f32 v191, v211, v215
ds_write_b128 v36, v[188:191] offset:192
ds_read_b128 v[156:159], v36 offset:192
v_mfma_f32_16x16x32_bf16 v[216:219], v[56:59], v[192:195], 0
v_mfma_f32_16x16x32_bf16 v[220:223], v[60:63], v[196:199], 0
v_lshlrev_b32 v30, 16, v2
v_and_b32 v31, 0xffff0000, v2
s_waitcnt lgkmcnt(2)
v_pk_add_f32 v[20:21], v[20:21], v[22:23]
v_pk_add_f32 v[24:25], v[24:25], v[26:27]
v_pk_fma_f32 v[28:29], v[28:29], v[34:35], v[32:33] op_sel_hi:[0,1,1]
v_pk_add_f32 v[20:21], v[20:21], v[24:25]
v_pk_fma_f32 v[20:21], v[30:31], v[28:29], v[20:21]
v_cvt_pk_bf16_f32 v20, v20, v21
global_store_dword v6, v20, s[42:43]
L_hs30:
v_mfma_f32_16x16x32_bf16 v[232:235], v[104:107], v[168:171], v[232:235]
v_mfma_f32_16x16x32_bf16 v[236:239], v[108:111], v[168:171], v[236:239]
s_nop 1
v_cvt_pk_bf16_f32 v188, v216, v220
v_cvt_pk_bf16_f32 v189, v217, v221
v_cvt_pk_bf16_f32 v190, v218, v222
v_cvt_pk_bf16_f32 v191, v219, v223
ds_write_b128 v36, v[188:191] offset:256
ds_read_b128 v[160:163], v36 offset:256
v_mfma_f32_16x16x32_bf16 v[232:235], v[120:123], v[176:179], v[232:235]
v_mfma_f32_16x16x32_bf16 v[236:239], v[124:127], v[176:179], v[236:239]
v_mfma_f32_16x16x32_bf16 v[232:235], v[112:115], v[184:187], v[232:235]
v_mfma_f32_16x16x32_bf16 v[236:239], v[116:119], v[184:187], v[236:239]
ds_read_b128 v[164:167], v10 offset:1568
ds_read_b128 v[172:175], v10 offset:1632
ds_read_b128 v[180:183], v10 offset:576
ds_read_b128 v[168:171], v10 offset:2080
ds_read_b128 v[176:179], v10 offset:2144
ds_read_b128 v[184:187], v10 offset:1088
ds_read2_b32 v[88:89], v204 offset0:48 offset1:49
ds_read2_b32 v[90:91], v204 offset0:50 offset1:51
ds_read2_b32 v[92:93], v205 offset0:48 offset1:49
ds_read2_b32 v[94:95], v205 offset0:50 offset1:51
ds_read2_b32 v[80:81], v204 offset0:32 offset1:33
ds_read2_b32 v[82:83], v204 offset0:34 offset1:35
ds_read2_b32 v[84:85], v205 offset0:32 offset1:33
ds_read2_b32 v[86:87], v205 offset0:34 offset1:35
s_waitcnt lgkmcnt(4)
v_mfma_f32_16x16x32_bf16 v[128:131], v[144:147], v[88:91], 0
v_mfma_f32_16x16x32_bf16 v[132:135], v[144:147], v[92:95], 0
v_mfma_f32_16x16x32_bf16 v[128:131], v[148:151], v[96:99], v[128:131]
v_mfma_f32_16x16x32_bf16 v[132:135], v[148:151], v[100:103], v[132:135]
v_pk_add_f32 v[224:225], v[224:225], v[228:229] neg_lo:[0,1] neg_hi:[0,1]
v_pk_add_f32 v[226:227], v[226:227], v[230:231] neg_lo:[0,1] neg_hi:[0,1]
v_pk_fma_f32 v[224:225], v[40:41], v[224:225], v[228:229]
v_pk_fma_f32 v[226:227], v[42:43], v[226:227], v[230:231]
ds_write_b128 v11, v[224:227] offset:16384
v_pk_add_f32 v[232:233], v[232:233], v[236:237] neg_lo:[0,1] neg_hi:[0,1]
v_pk_add_f32 v[234:235], v[234:235], v[238:239] neg_lo:[0,1] neg_hi:[0,1]
v_pk_fma_f32 v[232:233], v[44:45], v[232:233], v[236:237]
v_pk_fma_f32 v[234:235], v[46:47], v[234:235], v[238:239]
ds_write_b128 v11, v[232:235] offset:17408
ds_read_b128 v[40:43], v12 offset:4096
ds_read_b128 v[44:47], v12 offset:5120
s_waitcnt lgkmcnt(4)
v_mfma_f32_16x16x32_bf16 v[136:139], v[144:147], v[80:83], 0
v_mfma_f32_16x16x32_bf16 v[140:143], v[144:147], v[84:87], 0
s_waitcnt lgkmcnt(0)
s_barrier
ds_read2st64_b32 v[20:21], v8 offset0:64 offset1:96
ds_read2st64_b32 v[22:23], v8 offset0:72 offset1:104
ds_read2st64_b32 v[24:25], v8 offset0:80 offset1:112
ds_read2st64_b32 v[26:27], v8 offset0:88 offset1:120
ds_read_b32 v28, v9 offset:2048
v_mfma_f32_16x16x32_bf16 v[136:139], v[148:151], v[88:91], v[136:139]
v_mfma_f32_16x16x32_bf16 v[140:143], v[148:151], v[92:95], v[140:143]
v_mfma_f32_16x16x32_bf16 v[136:139], v[152:155], v[96:99], v[136:139]
v_mfma_f32_16x16x32_bf16 v[140:143], v[152:155], v[100:103], v[140:143]
v_lshlrev_b32 v30, 16, v3
v_and_b32 v31, 0xffff0000, v3
v_add_u32 v15, 524288, v6
s_waitcnt lgkmcnt(0)
v_pk_add_f32 v[20:21], v[20:21], v[22:23]
v_pk_add_f32 v[24:25], v[24:25], v[26:27]
v_pk_fma_f32 v[28:29], v[28:29], v[34:35], v[32:33] op_sel_hi:[0,1,1]
v_pk_add_f32 v[20:21], v[20:21], v[24:25]
v_pk_fma_f32 v[20:21], v[30:31], v[28:29], v[20:21]
v_cvt_pk_bf16_f32 v20, v20, v21
global_store_dword v15, v20, s[42:43]
L_hs31:
v_mfma_f32_16x16x32_bf16 v[128:131], v[104:107], v[164:167], v[128:131]
v_mfma_f32_16x16x32_bf16 v[132:135], v[108:111], v[164:167], v[132:135]
v_mfma_f32_16x16x32_bf16 v[128:131], v[120:123], v[172:175], v[128:131]
v_mfma_f32_16x16x32_bf16 v[132:135], v[124:127], v[172:175], v[132:135]
v_mfma_f32_16x16x32_bf16 v[128:131], v[112:115], v[180:183], v[128:131]
v_mfma_f32_16x16x32_bf16 v[132:135], v[116:119], v[180:183], v[132:135]
v_mfma_f32_16x16x32_bf16 v[136:139], v[104:107], v[168:171], v[136:139]
v_mfma_f32_16x16x32_bf16 v[140:143], v[108:111], v[168:171], v[140:143]
v_mfma_f32_16x16x32_bf16 v[136:139], v[120:123], v[176:179], v[136:139]
v_mfma_f32_16x16x32_bf16 v[140:143], v[124:127], v[176:179], v[140:143]
v_mfma_f32_16x16x32_bf16 v[136:139], v[112:115], v[184:187], v[136:139]
v_mfma_f32_16x16x32_bf16 v[140:143], v[116:119], v[184:187], v[140:143]
ds_read_b128 v[164:167], v10 offset:2592
ds_read_b128 v[172:175], v10 offset:2656
ds_read_b128 v[180:183], v10 offset:1600
ds_read_b128 v[168:171], v10 offset:3104
ds_read_b128 v[176:179], v10 offset:3168
ds_read_b128 v[184:187], v10 offset:2112
ds_read2_b32 v[72:73], v204 offset0:16 offset1:17
ds_read2_b32 v[74:75], v204 offset0:18 offset1:19
ds_read2_b32 v[76:77], v205 offset0:16 offset1:17
ds_read2_b32 v[78:79], v205 offset0:18 offset1:19
ds_read2_b32 v[64:65], v204 offset0:0 offset1:1
ds_read2_b32 v[66:67], v204 offset0:2 offset1:3
ds_read2_b32 v[68:69], v205 offset0:0 offset1:1
ds_read2_b32 v[70:71], v205 offset0:2 offset1:3
s_waitcnt lgkmcnt(4)
v_mfma_f32_16x16x32_bf16 v[224:227], v[144:147], v[72:75], 0
v_mfma_f32_16x16x32_bf16 v[228:231], v[144:147], v[76:79], 0
v_mfma_f32_16x16x32_bf16 v[224:227], v[148:151], v[80:83], v[224:227]
v_mfma_f32_16x16x32_bf16 v[228:231], v[148:151], v[84:87], v[228:231]
v_pk_add_f32 v[128:129], v[128:129], v[132:133] neg_lo:[0,1] neg_hi:[0,1]
v_pk_add_f32 v[130:131], v[130:131], v[134:135] neg_lo:[0,1] neg_hi:[0,1]
v_pk_fma_f32 v[128:129], v[40:41], v[128:129], v[132:133]
v_pk_fma_f32 v[130:131], v[42:43], v[130:131], v[134:135]
ds_write_b128 v11, v[128:131] offset:32768
v_pk_add_f32 v[136:137], v[136:137], v[140:141] neg_lo:[0,1] neg_hi:[0,1]
v_pk_add_f32 v[138:139], v[138:139], v[142:143] neg_lo:[0,1] neg_hi:[0,1]
v_pk_fma_f32 v[136:137], v[44:45], v[136:137], v[140:141]
v_pk_fma_f32 v[138:139], v[46:47], v[138:139], v[142:143]
ds_write_b128 v11, v[136:139] offset:33792
ds_read_b128 v[40:43], v12 offset:6144
ds_read_b128 v[44:47], v12 offset:7168
v_mfma_f32_16x16x32_bf16 v[224:227], v[152:155], v[88:91], v[224:227]
v_mfma_f32_16x16x32_bf16 v[228:231], v[152:155], v[92:95], v[228:231]
v_mfma_f32_16x16x32_bf16 v[224:227], v[156:159], v[96:99], v[224:227]
v_mfma_f32_16x16x32_bf16 v[228:231], v[156:159], v[100:103], v[228:231]
s_waitcnt lgkmcnt(4)
v_mfma_f32_16x16x32_bf16 v[232:235], v[144:147], v[64:67], 0
v_mfma_f32_16x16x32_bf16 v[236:239], v[144:147], v[68:71], 0
s_waitcnt lgkmcnt(0)
s_barrier
ds_read2st64_b32 v[20:21], v8 offset0:128 offset1:160
ds_read2st64_b32 v[22:23], v8 offset0:136 offset1:168
ds_read2st64_b32 v[24:25], v8 offset0:144 offset1:176
ds_read2st64_b32 v[26:27], v8 offset0:152 offset1:184
ds_read_b32 v28, v9 offset:4096
v_mfma_f32_16x16x32_bf16 v[232:235], v[148:151], v[72:75], v[232:235]
v_mfma_f32_16x16x32_bf16 v[236:239], v[148:151], v[76:79], v[236:239]
v_mfma_f32_16x16x32_bf16 v[232:235], v[152:155], v[80:83], v[232:235]
v_mfma_f32_16x16x32_bf16 v[236:239], v[152:155], v[84:87], v[236:239]
v_lshlrev_b32 v30, 16, v4
v_and_b32 v31, 0xffff0000, v4
v_add_u32 v15, 1048576, v6
s_waitcnt lgkmcnt(0)
v_pk_add_f32 v[20:21], v[20:21], v[22:23]
v_pk_add_f32 v[24:25], v[24:25], v[26:27]
v_pk_fma_f32 v[28:29], v[28:29], v[34:35], v[32:33] op_sel_hi:[0,1,1]
v_pk_add_f32 v[20:21], v[20:21], v[24:25]
v_pk_fma_f32 v[20:21], v[30:31], v[28:29], v[20:21]
v_cvt_pk_bf16_f32 v20, v20, v21
global_store_dword v15, v20, s[42:43]
L_hs32:
v_mfma_f32_16x16x32_bf16 v[232:235], v[156:159], v[88:91], v[232:235]
v_mfma_f32_16x16x32_bf16 v[236:239], v[156:159], v[92:95], v[236:239]
v_mfma_f32_16x16x32_bf16 v[232:235], v[160:163], v[96:99], v[232:235]
v_mfma_f32_16x16x32_bf16 v[236:239], v[160:163], v[100:103], v[236:239]
v_mfma_f32_16x16x32_bf16 v[224:227], v[104:107], v[164:167], v[224:227]
v_mfma_f32_16x16x32_bf16 v[228:231], v[108:111], v[164:167], v[228:231]
v_mfma_f32_16x16x32_bf16 v[224:227], v[120:123], v[172:175], v[224:227]
v_mfma_f32_16x16x32_bf16 v[228:231], v[124:127], v[172:175], v[228:231]
v_mfma_f32_16x16x32_bf16 v[224:227], v[112:115], v[180:183], v[224:227]
v_mfma_f32_16x16x32_bf16 v[228:231], v[116:119], v[180:183], v[228:231]
v_mfma_f32_16x16x32_bf16 v[232:235], v[104:107], v[168:171], v[232:235]
v_mfma_f32_16x16x32_bf16 v[236:239], v[108:111], v[168:171], v[236:239]
v_mfma_f32_16x16x32_bf16 v[232:235], v[120:123], v[176:179], v[232:235]
v_mfma_f32_16x16x32_bf16 v[236:239], v[124:127], v[176:179], v[236:239]
v_mfma_f32_16x16x32_bf16 v[232:235], v[112:115], v[184:187], v[232:235]
v_mfma_f32_16x16x32_bf16 v[236:239], v[116:119], v[184:187], v[236:239]
s_nop 7
v_pk_add_f32 v[224:225], v[224:225], v[228:229] neg_lo:[0,1] neg_hi:[0,1]
v_pk_add_f32 v[226:227], v[226:227], v[230:231] neg_lo:[0,1] neg_hi:[0,1]
v_pk_fma_f32 v[224:225], v[40:41], v[224:225], v[228:229]
v_pk_fma_f32 v[226:227], v[42:43], v[226:227], v[230:231]
ds_write_b128 v11, v[224:227] offset:49152
v_pk_add_f32 v[232:233], v[232:233], v[236:237] neg_lo:[0,1] neg_hi:[0,1]
v_pk_add_f32 v[234:235], v[234:235], v[238:239] neg_lo:[0,1] neg_hi:[0,1]
v_pk_fma_f32 v[232:233], v[44:45], v[232:233], v[236:237]
v_pk_fma_f32 v[234:235], v[46:47], v[234:235], v[238:239]
ds_write_b128 v11, v[232:235] offset:50176
s_waitcnt lgkmcnt(0)
s_barrier
ds_read2st64_b32 v[20:21], v8 offset0:192 offset1:224
ds_read2st64_b32 v[22:23], v8 offset0:200 offset1:232
ds_read2st64_b32 v[24:25], v8 offset0:208 offset1:240
ds_read2st64_b32 v[26:27], v8 offset0:216 offset1:248
ds_read_b32 v28, v9 offset:6144
v_lshlrev_b32 v30, 16, v5
v_and_b32 v31, 0xffff0000, v5
v_add_u32 v15, 1572864, v6
s_waitcnt lgkmcnt(0)
v_pk_add_f32 v[20:21], v[20:21], v[22:23]
v_pk_add_f32 v[24:25], v[24:25], v[26:27]
v_pk_fma_f32 v[28:29], v[28:29], v[34:35], v[32:33] op_sel_hi:[0,1,1]
v_pk_add_f32 v[20:21], v[20:21], v[24:25]
v_pk_fma_f32 v[20:21], v[30:31], v[28:29], v[20:21]
v_cvt_pk_bf16_f32 v20, v20, v21
global_store_dword v15, v20, s[42:43]
L_hs33:
L_fin:
L_end:
s_endpgm
.section .rodata,"a"
.p2align 6
.amdhsa_kernel gated_mix__ssm_conv_s4d__ssm_conv_s4__prompt_kernel
  .amdhsa_next_free_vgpr 240
  .amdhsa_next_free_sgpr 102
  .amdhsa_accum_offset 240
  .amdhsa_group_segment_fixed_size 0
  .amdhsa_kernarg_size 160
  .amdhsa_user_sgpr_count 2
  .amdhsa_user_sgpr_kernarg_segment_ptr 1
  .amdhsa_system_sgpr_workgroup_id_x 1
.end_amdhsa_kernel
```
